```python
import torch

def _softmax(x, axis=-1):
    return torch.softmax(x, dim=axis)
def _gelu(x):
    return torch.nn.functional.gelu(x, approximate="tanh")
def _silu(x):
    return torch.nn.functional.silu(x)
def _sigmoid(x):
    return torch.sigmoid(x)
def _layernorm(x, axis=-1, eps=1e-5):
    m = x.mean(dim=axis, keepdim=True)
    v = x.var(dim=axis, keepdim=True, unbiased=False)
    return (x - m) / torch.sqrt(v + eps)
def _scatter_add(tgt, idx, src, axis=0):
    return tgt.clone().index_add_(axis, idx, src)
def _segment_sum(src, seg, n):
    out = torch.zeros((n,) + src.shape[1:], dtype=src.dtype)
    return out.index_add_(0, seg, src)
def _pad(x, pw):
    flat = tuple(v for pair in reversed(pw) for v in pair)
    return torch.nn.functional.pad(x, flat)

kernel_name = 'standalone__weight_only_int_gptq__prompt'

def setup_inputs():

    _w = (lambda a: (lambda t: t.to(torch.bfloat16) if t.is_floating_point() else t)(torch.as_tensor(a)))
    B, S, D, F = 1, 2048, 576, 4608
    bits = max(2, min(4, 3))
    pf = 32 // bits
    G = -1 if -1 > 0 else D
    G = max(pf, (G // pf) * pf)
    D = max(G, (D // G) * G)
    ng = D // G
    qmax = 1 << bits
    qw = torch.randint(0, qmax, (D, F)).to(torch.int64)
    packed = torch.zeros((D // pf, F), dtype=torch.int64)
    for i in range(pf):
        packed |= (qw[i::pf] << (i * bits))
    packed = packed.to(torch.int32)
    return {
        "x": _w((lambda *s: torch.randn(*s, dtype=torch.bfloat16) * 0.05)(B, S, D)),
        "qw_packed": _w(packed),
        "scales": _w(torch.abs((lambda *s: torch.randn(*s, dtype=torch.bfloat16) * 0.05)(ng, F)).to(float) * 0.1 + 0.01),
        "zeros": _w(torch.randint(0, qmax, (ng, F)).to(float)),
        "bits": _w((lambda _x: torch.as_tensor(_x, dtype=torch.int32))(bits)),
    }

def reference(x, qw_packed, scales, zeros, bits):
    b = int(bits)
    pf = 32 // b
    mask = (1 << b) - 1
    P, F = qw_packed.shape
    D = P * pf
    ng = scales.shape[0]
    G = D // ng
    shifts = (lambda x, dt: x.to(dt))(torch.arange(pf) * b, qw_packed.dtype)
    qw = ((qw_packed[:, None, :] >> shifts[None, :, None]) & mask).reshape(D, F)
    s = (lambda x, n, axis: torch.repeat_interleave(x, n, dim=axis))(scales, G, axis=0)
    z = (lambda x, n, axis: torch.repeat_interleave(x, n, dim=axis))(zeros, G, axis=0)
    w = ((lambda x, dt: x.to(dt))(qw, x.dtype) - z) * s
    return torch.einsum("bsd,df->bsf", x, w)
```

```asm
; @launch grid=(256,1,1) block=(512,1,1) lds=163840
.amdgcn_target "amdgcn-amd-amdhsa--gfx950"
.text
.globl standalone__weight_only_int_gptq__prompt_kernel
.p2align 8
.type standalone__weight_only_int_gptq__prompt_kernel,@function
standalone__weight_only_int_gptq__prompt_kernel:
    s_cmp_ge_u32 s2, 256
    s_cbranch_scc1 L_END
    s_load_dwordx4 s[4:7], s[0:1], 0
    s_load_dwordx4 s[8:11], s[0:1], 16
    s_load_dwordx2 s[12:13], s[0:1], 40
    v_and_b32 v1, 63, v0
    v_lshrrev_b32 v16, 6, v0
    s_nop 0
    v_readfirstlane_b32 s46, v16
    s_and_b32 s14, s2, 7
    s_lshr_b32 s15, s2, 3
    s_mul_i32 s48, s15, 144
    s_lshl_b32 s47, s14, 8
    s_lshl_b32 s49, s46, 5
    s_add_u32 s47, s47, s49
    s_mov_b32 s36, 18240
    s_mov_b32 s37, 147456
    s_mov_b32 s38, 18432
    s_mov_b32 s39, 36864
    s_mov_b32 s40, 55296
    s_mov_b32 s41, 73728
    s_mov_b32 s42, 92160
    s_mov_b32 s43, 110592
    s_mov_b32 s44, 129024
    v_and_b32 v17, 15, v1
    v_lshrrev_b32 v18, 4, v1
    v_add_u32 v19, s47, v17
    v_mul_u32_u24 v20, 1140, v19
    v_lshl_add_u32 v2, v18, 4, v20
    v_lshlrev_b32 v20, 4, v17
    v_lshl_add_u32 v3, v18, 10, v20
    v_mul_u32_u24 v20, 4608, v19
    v_add_u32 v20, s48, v20
    v_lshl_add_u32 v20, v18, 3, v20
    v_lshlrev_b32 v6, 1, v20
    v_and_b32 v20, 32, v1
    v_lshrrev_b32 v21, 2, v17
    v_lshl_add_u32 v20, v21, 3, v20
    v_and_b32 v21, 1, v18
    v_lshl_add_u32 v20, v21, 2, v20
    v_and_b32 v21, 3, v17
    v_add_u32 v20, v20, v21
    v_add_u32 v20, s48, v20
    v_lshlrev_b32 v7, 1, v20
    s_mul_i32 s49, s46, 36864
    v_add_u32 v20, s49, v20
    v_lshlrev_b32 v5, 2, v20
    s_mul_i32 s49, s46, 10240
    v_lshlrev_b32 v20, 4, v1
    v_add_u32 v4, s49, v20
    s_waitcnt lgkmcnt(0)
    s_mov_b32 s16, s4
    s_and_b32 s17, s5, 0xffff
    s_mov_b32 s18, 2334720
    s_mov_b32 s19, 0x20000
    s_mov_b32 s20, s6
    s_and_b32 s21, s7, 0xffff
    s_mov_b32 s22, 1050624
    s_mov_b32 s23, 0x20000
    s_mov_b32 s24, s8
    s_and_b32 s25, s9, 0xffff
    s_mov_b32 s26, 9216
    s_mov_b32 s27, 0x20000
    s_mov_b32 s28, s10
    s_and_b32 s29, s11, 0xffff
    s_mov_b32 s30, 9216
    s_mov_b32 s31, 0x20000
    s_mov_b32 s32, s12
    s_and_b32 s33, s13, 0xffff
    s_mov_b32 s34, 18874368
    s_mov_b32 s35, 0x20000
    buffer_load_ushort v32, v7, s[24:27], 0 offen offset:0
    buffer_load_ushort v33, v7, s[28:31], 0 offen offset:0
    buffer_load_dword v24, v5, s[20:23], 0 offen offset:0
    buffer_load_dword v25, v5, s[20:23], s38 offen offset:0
    buffer_load_dword v26, v5, s[20:23], s39 offen offset:0
    buffer_load_dword v27, v5, s[20:23], s40 offen offset:0
    buffer_load_dword v28, v5, s[20:23], s41 offen offset:0
    buffer_load_dword v29, v5, s[20:23], s42 offen offset:0
    buffer_load_dword v30, v5, s[20:23], s43 offen offset:0
    buffer_load_dword v31, v5, s[20:23], s44 offen offset:0
    buffer_load_ushort v44, v7, s[24:27], 0 offen offset:128
    buffer_load_ushort v45, v7, s[28:31], 0 offen offset:128
    buffer_load_dword v36, v5, s[20:23], 0 offen offset:256
    buffer_load_dword v37, v5, s[20:23], s38 offen offset:256
    buffer_load_dword v38, v5, s[20:23], s39 offen offset:256
    buffer_load_dword v39, v5, s[20:23], s40 offen offset:256
    buffer_load_dword v40, v5, s[20:23], s41 offen offset:256
    buffer_load_dword v41, v5, s[20:23], s42 offen offset:256
    buffer_load_dword v42, v5, s[20:23], s43 offen offset:256
    buffer_load_dword v43, v5, s[20:23], s44 offen offset:256
    buffer_load_dwordx4 v[112:115], v2, s[16:19], 0 offen offset:0
    buffer_load_dwordx4 v[116:119], v2, s[16:19], s36 offen offset:0
    buffer_load_dwordx4 v[120:123], v2, s[16:19], 0 offen offset:64
    buffer_load_dwordx4 v[124:127], v2, s[16:19], s36 offen offset:64
    buffer_load_dwordx4 v[128:131], v2, s[16:19], 0 offen offset:128
    buffer_load_dwordx4 v[132:135], v2, s[16:19], s36 offen offset:128
    buffer_load_dwordx4 v[136:139], v2, s[16:19], 0 offen offset:192
    buffer_load_dwordx4 v[140:143], v2, s[16:19], s36 offen offset:192
    buffer_load_dwordx4 v[144:147], v2, s[16:19], 0 offen offset:256
    buffer_load_dwordx4 v[148:151], v2, s[16:19], s36 offen offset:256
    buffer_load_dwordx4 v[152:155], v2, s[16:19], 0 offen offset:320
    buffer_load_dwordx4 v[156:159], v2, s[16:19], s36 offen offset:320
    buffer_load_dwordx4 v[160:163], v2, s[16:19], 0 offen offset:384
    buffer_load_dwordx4 v[164:167], v2, s[16:19], s36 offen offset:384
    buffer_load_dwordx4 v[168:171], v2, s[16:19], 0 offen offset:448
    buffer_load_dwordx4 v[172:175], v2, s[16:19], s36 offen offset:448
    buffer_load_dwordx4 v[176:179], v2, s[16:19], 0 offen offset:512
    buffer_load_dwordx4 v[180:183], v2, s[16:19], s36 offen offset:512
    buffer_load_dwordx4 v[184:187], v2, s[16:19], 0 offen offset:576
    buffer_load_dwordx4 v[188:191], v2, s[16:19], s36 offen offset:576
    buffer_load_dwordx4 v[192:195], v2, s[16:19], 0 offen offset:640
    buffer_load_dwordx4 v[196:199], v2, s[16:19], s36 offen offset:640
    buffer_load_dwordx4 v[200:203], v2, s[16:19], 0 offen offset:704
    buffer_load_dwordx4 v[204:207], v2, s[16:19], s36 offen offset:704
    buffer_load_dwordx4 v[208:211], v2, s[16:19], 0 offen offset:768
    buffer_load_dwordx4 v[212:215], v2, s[16:19], s36 offen offset:768
    buffer_load_dwordx4 v[216:219], v2, s[16:19], 0 offen offset:832
    buffer_load_dwordx4 v[220:223], v2, s[16:19], s36 offen offset:832
    buffer_load_dwordx4 v[224:227], v2, s[16:19], 0 offen offset:896
    buffer_load_dwordx4 v[228:231], v2, s[16:19], s36 offen offset:896
    buffer_load_dwordx4 v[232:235], v2, s[16:19], 0 offen offset:960
    buffer_load_dwordx4 v[236:239], v2, s[16:19], s36 offen offset:960
    buffer_load_dwordx4 v[240:243], v2, s[16:19], 0 offen offset:1024
    buffer_load_dwordx4 v[244:247], v2, s[16:19], s36 offen offset:1024
    buffer_load_dwordx4 v[248:251], v2, s[16:19], 0 offen offset:1088
    buffer_load_dwordx4 v[252:255], v2, s[16:19], s36 offen offset:1088
    s_waitcnt vmcnt(46)
    v_lshlrev_b32 v32, 16, v32
    v_lshlrev_b32 v33, 16, v33
    v_mul_f32 v33, v33, v32
    v_mov_b32 v16, s46
    v_cmp_ne_u32 vcc, 7, v16
    s_nop 1
    v_cndmask_b32 v34, 0, v32, vcc
    v_cndmask_b32 v35, 0, v33, vcc
    v_bfe_u32 v16, v24, 0, 3
    v_bfe_u32 v17, v24, 3, 3
    v_bfe_u32 v18, v24, 6, 3
    v_bfe_u32 v19, v24, 9, 3
    v_cvt_f32_u32 v16, v16
    v_cvt_f32_u32 v17, v17
    v_cvt_f32_u32 v18, v18
    v_cvt_f32_u32 v19, v19
    v_fma_f32 v16, v16, v32, -v33
    v_fma_f32 v17, v17, v32, -v33
    v_fma_f32 v18, v18, v32, -v33
    v_fma_f32 v19, v19, v32, -v33
    v_cvt_pk_bf16_f32 v8, v16, v17
    v_cvt_pk_bf16_f32 v9, v18, v19
    v_bfe_u32 v20, v24, 12, 3
    v_bfe_u32 v21, v24, 15, 3
    v_bfe_u32 v22, v24, 18, 3
    v_bfe_u32 v23, v24, 21, 3
    v_cvt_f32_u32 v20, v20
    v_cvt_f32_u32 v21, v21
    v_cvt_f32_u32 v22, v22
    v_cvt_f32_u32 v23, v23
    v_fma_f32 v20, v20, v32, -v33
    v_fma_f32 v21, v21, v32, -v33
    v_fma_f32 v22, v22, v32, -v33
    v_fma_f32 v23, v23, v32, -v33
    v_cvt_pk_bf16_f32 v10, v20, v21
    v_cvt_pk_bf16_f32 v11, v22, v23
    ds_write_b128 v4, v[8:11] offset:0
    v_bfe_u32 v16, v24, 24, 3
    v_bfe_u32 v17, v24, 27, 3
    v_bfe_u32 v18, v25, 0, 3
    v_bfe_u32 v19, v25, 3, 3
    v_cvt_f32_u32 v16, v16
    v_cvt_f32_u32 v17, v17
    v_cvt_f32_u32 v18, v18
    v_cvt_f32_u32 v19, v19
    v_fma_f32 v16, v16, v32, -v33
    v_fma_f32 v17, v17, v32, -v33
    v_fma_f32 v18, v18, v34, -v35
    v_fma_f32 v19, v19, v34, -v35
    v_cvt_pk_bf16_f32 v12, v16, v17
    v_cvt_pk_bf16_f32 v13, v18, v19
    v_bfe_u32 v20, v25, 6, 3
    v_bfe_u32 v21, v25, 9, 3
    v_bfe_u32 v22, v25, 12, 3
    v_bfe_u32 v23, v25, 15, 3
    v_cvt_f32_u32 v20, v20
    v_cvt_f32_u32 v21, v21
    v_cvt_f32_u32 v22, v22
    v_cvt_f32_u32 v23, v23
    v_fma_f32 v20, v20, v34, -v35
    v_fma_f32 v21, v21, v34, -v35
    v_fma_f32 v22, v22, v34, -v35
    v_fma_f32 v23, v23, v34, -v35
    v_cvt_pk_bf16_f32 v14, v20, v21
    v_cvt_pk_bf16_f32 v15, v22, v23
    ds_write_b128 v4, v[12:15] offset:1024
    v_bfe_u32 v16, v25, 18, 3
    v_bfe_u32 v17, v25, 21, 3
    v_bfe_u32 v18, v25, 24, 3
    v_bfe_u32 v19, v25, 27, 3
    v_cvt_f32_u32 v16, v16
    v_cvt_f32_u32 v17, v17
    v_cvt_f32_u32 v18, v18
    v_cvt_f32_u32 v19, v19
    v_fma_f32 v16, v16, v34, -v35
    v_fma_f32 v17, v17, v34, -v35
    v_fma_f32 v18, v18, v34, -v35
    v_fma_f32 v19, v19, v34, -v35
    v_cvt_pk_bf16_f32 v8, v16, v17
    v_cvt_pk_bf16_f32 v9, v18, v19
    v_bfe_u32 v20, v26, 0, 3
    v_bfe_u32 v21, v26, 3, 3
    v_bfe_u32 v22, v26, 6, 3
    v_bfe_u32 v23, v26, 9, 3
    v_cvt_f32_u32 v20, v20
    v_cvt_f32_u32 v21, v21
    v_cvt_f32_u32 v22, v22
    v_cvt_f32_u32 v23, v23
    v_fma_f32 v20, v20, v34, -v35
    v_fma_f32 v21, v21, v34, -v35
    v_fma_f32 v22, v22, v34, -v35
    v_fma_f32 v23, v23, v34, -v35
    v_cvt_pk_bf16_f32 v10, v20, v21
    v_cvt_pk_bf16_f32 v11, v22, v23
    ds_write_b128 v4, v[8:11] offset:2048
    v_bfe_u32 v16, v26, 12, 3
    v_bfe_u32 v17, v26, 15, 3
    v_bfe_u32 v18, v26, 18, 3
    v_bfe_u32 v19, v26, 21, 3
    v_cvt_f32_u32 v16, v16
    v_cvt_f32_u32 v17, v17
    v_cvt_f32_u32 v18, v18
    v_cvt_f32_u32 v19, v19
    v_fma_f32 v16, v16, v34, -v35
    v_fma_f32 v17, v17, v34, -v35
    v_fma_f32 v18, v18, v34, -v35
    v_fma_f32 v19, v19, v34, -v35
    v_cvt_pk_bf16_f32 v12, v16, v17
    v_cvt_pk_bf16_f32 v13, v18, v19
    v_bfe_u32 v20, v26, 24, 3
    v_bfe_u32 v21, v26, 27, 3
    v_bfe_u32 v22, v27, 0, 3
    v_bfe_u32 v23, v27, 3, 3
    v_cvt_f32_u32 v20, v20
    v_cvt_f32_u32 v21, v21
    v_cvt_f32_u32 v22, v22
    v_cvt_f32_u32 v23, v23
    v_fma_f32 v20, v20, v34, -v35
    v_fma_f32 v21, v21, v34, -v35
    v_fma_f32 v22, v22, v34, -v35
    v_fma_f32 v23, v23, v34, -v35
    v_cvt_pk_bf16_f32 v14, v20, v21
    v_cvt_pk_bf16_f32 v15, v22, v23
    ds_write_b128 v4, v[12:15] offset:3072
    v_bfe_u32 v16, v27, 6, 3
    v_bfe_u32 v17, v27, 9, 3
    v_bfe_u32 v18, v27, 12, 3
    v_bfe_u32 v19, v27, 15, 3
    v_cvt_f32_u32 v16, v16
    v_cvt_f32_u32 v17, v17
    v_cvt_f32_u32 v18, v18
    v_cvt_f32_u32 v19, v19
    v_fma_f32 v16, v16, v34, -v35
    v_fma_f32 v17, v17, v34, -v35
    v_fma_f32 v18, v18, v34, -v35
    v_fma_f32 v19, v19, v34, -v35
    v_cvt_pk_bf16_f32 v8, v16, v17
    v_cvt_pk_bf16_f32 v9, v18, v19
    v_bfe_u32 v20, v27, 18, 3
    v_bfe_u32 v21, v27, 21, 3
    v_bfe_u32 v22, v27, 24, 3
    v_bfe_u32 v23, v27, 27, 3
    v_cvt_f32_u32 v20, v20
    v_cvt_f32_u32 v21, v21
    v_cvt_f32_u32 v22, v22
    v_cvt_f32_u32 v23, v23
    v_fma_f32 v20, v20, v34, -v35
    v_fma_f32 v21, v21, v34, -v35
    v_fma_f32 v22, v22, v34, -v35
    v_fma_f32 v23, v23, v34, -v35
    v_cvt_pk_bf16_f32 v10, v20, v21
    v_cvt_pk_bf16_f32 v11, v22, v23
    ds_write_b128 v4, v[8:11] offset:4096
    v_bfe_u32 v16, v28, 0, 3
    v_bfe_u32 v17, v28, 3, 3
    v_bfe_u32 v18, v28, 6, 3
    v_bfe_u32 v19, v28, 9, 3
    v_cvt_f32_u32 v16, v16
    v_cvt_f32_u32 v17, v17
    v_cvt_f32_u32 v18, v18
    v_cvt_f32_u32 v19, v19
    v_fma_f32 v16, v16, v34, -v35
    v_fma_f32 v17, v17, v34, -v35
    v_fma_f32 v18, v18, v34, -v35
    v_fma_f32 v19, v19, v34, -v35
    v_cvt_pk_bf16_f32 v12, v16, v17
    v_cvt_pk_bf16_f32 v13, v18, v19
    v_bfe_u32 v20, v28, 12, 3
    v_bfe_u32 v21, v28, 15, 3
    v_bfe_u32 v22, v28, 18, 3
    v_bfe_u32 v23, v28, 21, 3
    v_cvt_f32_u32 v20, v20
    v_cvt_f32_u32 v21, v21
    v_cvt_f32_u32 v22, v22
    v_cvt_f32_u32 v23, v23
    v_fma_f32 v20, v20, v34, -v35
    v_fma_f32 v21, v21, v34, -v35
    v_fma_f32 v22, v22, v34, -v35
    v_fma_f32 v23, v23, v34, -v35
    v_cvt_pk_bf16_f32 v14, v20, v21
    v_cvt_pk_bf16_f32 v15, v22, v23
    ds_write_b128 v4, v[12:15] offset:5120
    v_bfe_u32 v16, v28, 24, 3
    v_bfe_u32 v17, v28, 27, 3
    v_bfe_u32 v18, v29, 0, 3
    v_bfe_u32 v19, v29, 3, 3
    v_cvt_f32_u32 v16, v16
    v_cvt_f32_u32 v17, v17
    v_cvt_f32_u32 v18, v18
    v_cvt_f32_u32 v19, v19
    v_fma_f32 v16, v16, v34, -v35
    v_fma_f32 v17, v17, v34, -v35
    v_fma_f32 v18, v18, v34, -v35
    v_fma_f32 v19, v19, v34, -v35
    v_cvt_pk_bf16_f32 v8, v16, v17
    v_cvt_pk_bf16_f32 v9, v18, v19
    v_bfe_u32 v20, v29, 6, 3
    v_bfe_u32 v21, v29, 9, 3
    v_bfe_u32 v22, v29, 12, 3
    v_bfe_u32 v23, v29, 15, 3
    v_cvt_f32_u32 v20, v20
    v_cvt_f32_u32 v21, v21
    v_cvt_f32_u32 v22, v22
    v_cvt_f32_u32 v23, v23
    v_fma_f32 v20, v20, v34, -v35
    v_fma_f32 v21, v21, v34, -v35
    v_fma_f32 v22, v22, v34, -v35
    v_fma_f32 v23, v23, v34, -v35
    v_cvt_pk_bf16_f32 v10, v20, v21
    v_cvt_pk_bf16_f32 v11, v22, v23
    ds_write_b128 v4, v[8:11] offset:6144
    v_bfe_u32 v16, v29, 18, 3
    v_bfe_u32 v17, v29, 21, 3
    v_bfe_u32 v18, v29, 24, 3
    v_bfe_u32 v19, v29, 27, 3
    v_cvt_f32_u32 v16, v16
    v_cvt_f32_u32 v17, v17
    v_cvt_f32_u32 v18, v18
    v_cvt_f32_u32 v19, v19
    v_fma_f32 v16, v16, v34, -v35
    v_fma_f32 v17, v17, v34, -v35
    v_fma_f32 v18, v18, v34, -v35
    v_fma_f32 v19, v19, v34, -v35
    v_cvt_pk_bf16_f32 v12, v16, v17
    v_cvt_pk_bf16_f32 v13, v18, v19
    v_bfe_u32 v20, v30, 0, 3
    v_bfe_u32 v21, v30, 3, 3
    v_bfe_u32 v22, v30, 6, 3
    v_bfe_u32 v23, v30, 9, 3
    v_cvt_f32_u32 v20, v20
    v_cvt_f32_u32 v21, v21
    v_cvt_f32_u32 v22, v22
    v_cvt_f32_u32 v23, v23
    v_fma_f32 v20, v20, v34, -v35
    v_fma_f32 v21, v21, v34, -v35
    v_fma_f32 v22, v22, v34, -v35
    v_fma_f32 v23, v23, v34, -v35
    v_cvt_pk_bf16_f32 v14, v20, v21
    v_cvt_pk_bf16_f32 v15, v22, v23
    ds_write_b128 v4, v[12:15] offset:7168
    v_bfe_u32 v16, v30, 12, 3
    v_bfe_u32 v17, v30, 15, 3
    v_bfe_u32 v18, v30, 18, 3
    v_bfe_u32 v19, v30, 21, 3
    v_cvt_f32_u32 v16, v16
    v_cvt_f32_u32 v17, v17
    v_cvt_f32_u32 v18, v18
    v_cvt_f32_u32 v19, v19
    v_fma_f32 v16, v16, v34, -v35
    v_fma_f32 v17, v17, v34, -v35
    v_fma_f32 v18, v18, v34, -v35
    v_fma_f32 v19, v19, v34, -v35
    v_cvt_pk_bf16_f32 v8, v16, v17
    v_cvt_pk_bf16_f32 v9, v18, v19
    v_bfe_u32 v20, v30, 24, 3
    v_bfe_u32 v21, v30, 27, 3
    v_bfe_u32 v22, v31, 0, 3
    v_bfe_u32 v23, v31, 3, 3
    v_cvt_f32_u32 v20, v20
    v_cvt_f32_u32 v21, v21
    v_cvt_f32_u32 v22, v22
    v_cvt_f32_u32 v23, v23
    v_fma_f32 v20, v20, v34, -v35
    v_fma_f32 v21, v21, v34, -v35
    v_fma_f32 v22, v22, v34, -v35
    v_fma_f32 v23, v23, v34, -v35
    v_cvt_pk_bf16_f32 v10, v20, v21
    v_cvt_pk_bf16_f32 v11, v22, v23
    ds_write_b128 v4, v[8:11] offset:8192
    v_bfe_u32 v16, v31, 6, 3
    v_bfe_u32 v17, v31, 9, 3
    v_bfe_u32 v18, v31, 12, 3
    v_bfe_u32 v19, v31, 15, 3
    v_cvt_f32_u32 v16, v16
    v_cvt_f32_u32 v17, v17
    v_cvt_f32_u32 v18, v18
    v_cvt_f32_u32 v19, v19
    v_fma_f32 v16, v16, v34, -v35
    v_fma_f32 v17, v17, v34, -v35
    v_fma_f32 v18, v18, v34, -v35
    v_fma_f32 v19, v19, v34, -v35
    v_cvt_pk_bf16_f32 v12, v16, v17
    v_cvt_pk_bf16_f32 v13, v18, v19
    v_bfe_u32 v20, v31, 18, 3
    v_bfe_u32 v21, v31, 21, 3
    v_bfe_u32 v22, v31, 24, 3
    v_bfe_u32 v23, v31, 27, 3
    v_cvt_f32_u32 v20, v20
    v_cvt_f32_u32 v21, v21
    v_cvt_f32_u32 v22, v22
    v_cvt_f32_u32 v23, v23
    v_fma_f32 v20, v20, v34, -v35
    v_fma_f32 v21, v21, v34, -v35
    v_fma_f32 v22, v22, v34, -v35
    v_fma_f32 v23, v23, v34, -v35
    v_cvt_pk_bf16_f32 v14, v20, v21
    v_cvt_pk_bf16_f32 v15, v22, v23
    ds_write_b128 v4, v[12:15] offset:9216
    s_waitcnt lgkmcnt(0)
    s_barrier
    v_add_u32 v1, 0, v3
    v_add_u32 v2, 36864, v3
    ds_read_b128 v[48:51], v1 offset:0
    ds_read_b128 v[52:55], v1 offset:256
    ds_read_b128 v[56:59], v1 offset:512
    ds_read_b128 v[60:63], v1 offset:768
    s_waitcnt lgkmcnt(0)
    s_waitcnt vmcnt(34)
    ds_read_b128 v[64:67], v1 offset:4096
    ds_read_b128 v[68:71], v1 offset:4352
    ds_read_b128 v[72:75], v1 offset:4608
    ds_read_b128 v[76:79], v1 offset:4864
    v_mfma_f32_16x16x32_bf16 v[80:83], v[48:51], v[112:115], 0
    v_mfma_f32_16x16x32_bf16 v[84:87], v[48:51], v[116:119], 0
    v_mfma_f32_16x16x32_bf16 v[88:91], v[52:55], v[112:115], 0
    v_mfma_f32_16x16x32_bf16 v[92:95], v[52:55], v[116:119], 0
    v_mfma_f32_16x16x32_bf16 v[96:99], v[56:59], v[112:115], 0
    v_mfma_f32_16x16x32_bf16 v[100:103], v[56:59], v[116:119], 0
    v_mfma_f32_16x16x32_bf16 v[104:107], v[60:63], v[112:115], 0
    v_mfma_f32_16x16x32_bf16 v[108:111], v[60:63], v[116:119], 0
    s_waitcnt lgkmcnt(0)
    s_waitcnt vmcnt(32)
    ds_read_b128 v[48:51], v1 offset:8192
    ds_read_b128 v[52:55], v1 offset:8448
    ds_read_b128 v[56:59], v1 offset:8704
    ds_read_b128 v[60:63], v1 offset:8960
    v_mfma_f32_16x16x32_bf16 v[80:83], v[64:67], v[120:123], v[80:83]
    v_add_u32 v4, 81920, v4
    v_lshlrev_b32 v44, 16, v44
    v_mfma_f32_16x16x32_bf16 v[84:87], v[64:67], v[124:127], v[84:87]
    v_lshlrev_b32 v45, 16, v45
    v_mul_f32 v45, v45, v44
    v_mfma_f32_16x16x32_bf16 v[88:91], v[68:71], v[120:123], v[88:91]
    v_mov_b32 v16, s46
    v_cmp_ne_u32 vcc, 7, v16
    s_nop 1
    v_mfma_f32_16x16x32_bf16 v[92:95], v[68:71], v[124:127], v[92:95]
    v_cndmask_b32 v46, 0, v44, vcc
    v_cndmask_b32 v47, 0, v45, vcc
    v_mfma_f32_16x16x32_bf16 v[96:99], v[72:75], v[120:123], v[96:99]
    v_bfe_u32 v16, v36, 0, 3
    v_bfe_u32 v17, v36, 3, 3
    v_mfma_f32_16x16x32_bf16 v[100:103], v[72:75], v[124:127], v[100:103]
    v_bfe_u32 v18, v36, 6, 3
    v_bfe_u32 v19, v36, 9, 3
    v_cvt_f32_u32 v16, v16
    v_mfma_f32_16x16x32_bf16 v[104:107], v[76:79], v[120:123], v[104:107]
    v_cvt_f32_u32 v17, v17
    v_cvt_f32_u32 v18, v18
    v_mfma_f32_16x16x32_bf16 v[108:111], v[76:79], v[124:127], v[108:111]
    v_cvt_f32_u32 v19, v19
    v_fma_f32 v16, v16, v44, -v45
    s_waitcnt lgkmcnt(0)
    s_waitcnt vmcnt(30)
    ds_read_b128 v[64:67], v1 offset:12288
    ds_read_b128 v[68:71], v1 offset:12544
    ds_read_b128 v[72:75], v1 offset:12800
    ds_read_b128 v[76:79], v1 offset:13056
    v_mfma_f32_16x16x32_bf16 v[80:83], v[48:51], v[128:131], v[80:83]
    v_fma_f32 v17, v17, v44, -v45
    v_fma_f32 v18, v18, v44, -v45
    v_fma_f32 v19, v19, v44, -v45
    v_mfma_f32_16x16x32_bf16 v[84:87], v[48:51], v[132:135], v[84:87]
    v_cvt_pk_bf16_f32 v8, v16, v17
    v_cvt_pk_bf16_f32 v9, v18, v19
    v_mfma_f32_16x16x32_bf16 v[88:91], v[52:55], v[128:131], v[88:91]
    v_bfe_u32 v20, v36, 12, 3
    v_bfe_u32 v21, v36, 15, 3
    v_mfma_f32_16x16x32_bf16 v[92:95], v[52:55], v[132:135], v[92:95]
    v_bfe_u32 v22, v36, 18, 3
    v_bfe_u32 v23, v36, 21, 3
    v_cvt_f32_u32 v20, v20
    v_mfma_f32_16x16x32_bf16 v[96:99], v[56:59], v[128:131], v[96:99]
    v_cvt_f32_u32 v21, v21
    v_cvt_f32_u32 v22, v22
    v_mfma_f32_16x16x32_bf16 v[100:103], v[56:59], v[132:135], v[100:103]
    v_cvt_f32_u32 v23, v23
    v_fma_f32 v20, v20, v44, -v45
    v_mfma_f32_16x16x32_bf16 v[104:107], v[60:63], v[128:131], v[104:107]
    v_fma_f32 v21, v21, v44, -v45
    v_fma_f32 v22, v22, v44, -v45
    v_fma_f32 v23, v23, v44, -v45
    v_mfma_f32_16x16x32_bf16 v[108:111], v[60:63], v[132:135], v[108:111]
    v_cvt_pk_bf16_f32 v10, v20, v21
    v_cvt_pk_bf16_f32 v11, v22, v23
    s_waitcnt lgkmcnt(0)
    s_waitcnt vmcnt(28)
    ds_read_b128 v[48:51], v1 offset:16384
    ds_read_b128 v[52:55], v1 offset:16640
    ds_read_b128 v[56:59], v1 offset:16896
    ds_read_b128 v[60:63], v1 offset:17152
    v_mfma_f32_16x16x32_bf16 v[80:83], v[64:67], v[136:139], v[80:83]
    ds_write_b128 v4, v[8:11] offset:0
    v_bfe_u32 v16, v36, 24, 3
    v_mfma_f32_16x16x32_bf16 v[84:87], v[64:67], v[140:143], v[84:87]
    v_bfe_u32 v17, v36, 27, 3
    v_bfe_u32 v18, v37, 0, 3
    v_bfe_u32 v19, v37, 3, 3
    v_mfma_f32_16x16x32_bf16 v[88:91], v[68:71], v[136:139], v[88:91]
    v_cvt_f32_u32 v16, v16
    v_cvt_f32_u32 v17, v17
    v_mfma_f32_16x16x32_bf16 v[92:95], v[68:71], v[140:143], v[92:95]
    v_cvt_f32_u32 v18, v18
    v_cvt_f32_u32 v19, v19
    v_mfma_f32_16x16x32_bf16 v[96:99], v[72:75], v[136:139], v[96:99]
    v_fma_f32 v16, v16, v44, -v45
    v_fma_f32 v17, v17, v44, -v45
    v_fma_f32 v18, v18, v46, -v47
    v_mfma_f32_16x16x32_bf16 v[100:103], v[72:75], v[140:143], v[100:103]
    v_fma_f32 v19, v19, v46, -v47
    v_cvt_pk_bf16_f32 v12, v16, v17
    v_mfma_f32_16x16x32_bf16 v[104:107], v[76:79], v[136:139], v[104:107]
    v_cvt_pk_bf16_f32 v13, v18, v19
    v_bfe_u32 v20, v37, 6, 3
    v_mfma_f32_16x16x32_bf16 v[108:111], v[76:79], v[140:143], v[108:111]
    v_bfe_u32 v21, v37, 9, 3
    v_bfe_u32 v22, v37, 12, 3
    v_bfe_u32 v23, v37, 15, 3
    s_waitcnt lgkmcnt(1)
    s_waitcnt vmcnt(26)
    ds_read_b128 v[64:67], v1 offset:20480
    ds_read_b128 v[68:71], v1 offset:20736
    ds_read_b128 v[72:75], v1 offset:20992
    ds_read_b128 v[76:79], v1 offset:21248
    v_mfma_f32_16x16x32_bf16 v[80:83], v[48:51], v[144:147], v[80:83]
    v_cvt_f32_u32 v20, v20
    v_cvt_f32_u32 v21, v21
    v_mfma_f32_16x16x32_bf16 v[84:87], v[48:51], v[148:151], v[84:87]
    v_cvt_f32_u32 v22, v22
    v_cvt_f32_u32 v23, v23
    v_mfma_f32_16x16x32_bf16 v[88:91], v[52:55], v[144:147], v[88:91]
    v_fma_f32 v20, v20, v46, -v47
    v_fma_f32 v21, v21, v46, -v47
    v_fma_f32 v22, v22, v46, -v47
    v_mfma_f32_16x16x32_bf16 v[92:95], v[52:55], v[148:151], v[92:95]
    v_fma_f32 v23, v23, v46, -v47
    v_cvt_pk_bf16_f32 v14, v20, v21
    v_mfma_f32_16x16x32_bf16 v[96:99], v[56:59], v[144:147], v[96:99]
    v_cvt_pk_bf16_f32 v15, v22, v23
    ds_write_b128 v4, v[12:15] offset:1024
    v_mfma_f32_16x16x32_bf16 v[100:103], v[56:59], v[148:151], v[100:103]
    v_bfe_u32 v16, v37, 18, 3
    v_bfe_u32 v17, v37, 21, 3
    v_bfe_u32 v18, v37, 24, 3
    v_mfma_f32_16x16x32_bf16 v[104:107], v[60:63], v[144:147], v[104:107]
    v_bfe_u32 v19, v37, 27, 3
    v_cvt_f32_u32 v16, v16
    v_mfma_f32_16x16x32_bf16 v[108:111], v[60:63], v[148:151], v[108:111]
    v_cvt_f32_u32 v17, v17
    v_cvt_f32_u32 v18, v18
    s_waitcnt lgkmcnt(1)
    s_waitcnt vmcnt(24)
    ds_read_b128 v[48:51], v1 offset:24576
    ds_read_b128 v[52:55], v1 offset:24832
    ds_read_b128 v[56:59], v1 offset:25088
    ds_read_b128 v[60:63], v1 offset:25344
    v_mfma_f32_16x16x32_bf16 v[80:83], v[64:67], v[152:155], v[80:83]
    v_cvt_f32_u32 v19, v19
    v_fma_f32 v16, v16, v46, -v47
    v_fma_f32 v17, v17, v46, -v47
    v_mfma_f32_16x16x32_bf16 v[84:87], v[64:67], v[156:159], v[84:87]
    v_fma_f32 v18, v18, v46, -v47
    v_fma_f32 v19, v19, v46, -v47
    v_mfma_f32_16x16x32_bf16 v[88:91], v[68:71], v[152:155], v[88:91]
    v_cvt_pk_bf16_f32 v8, v16, v17
    v_cvt_pk_bf16_f32 v9, v18, v19
    v_bfe_u32 v20, v38, 0, 3
    v_mfma_f32_16x16x32_bf16 v[92:95], v[68:71], v[156:159], v[92:95]
    v_bfe_u32 v21, v38, 3, 3
    v_bfe_u32 v22, v38, 6, 3
    v_mfma_f32_16x16x32_bf16 v[96:99], v[72:75], v[152:155], v[96:99]
    v_bfe_u32 v23, v38, 9, 3
    v_cvt_f32_u32 v20, v20
    v_mfma_f32_16x16x32_bf16 v[100:103], v[72:75], v[156:159], v[100:103]
    v_cvt_f32_u32 v21, v21
    v_cvt_f32_u32 v22, v22
    v_cvt_f32_u32 v23, v23
    v_mfma_f32_16x16x32_bf16 v[104:107], v[76:79], v[152:155], v[104:107]
    v_fma_f32 v20, v20, v46, -v47
    v_fma_f32 v21, v21, v46, -v47
    v_mfma_f32_16x16x32_bf16 v[108:111], v[76:79], v[156:159], v[108:111]
    v_fma_f32 v22, v22, v46, -v47
    v_fma_f32 v23, v23, v46, -v47
    s_waitcnt lgkmcnt(0)
    s_waitcnt vmcnt(22)
    ds_read_b128 v[64:67], v1 offset:28672
    ds_read_b128 v[68:71], v1 offset:28928
    ds_read_b128 v[72:75], v1 offset:29184
    ds_read_b128 v[76:79], v1 offset:29440
    v_mfma_f32_16x16x32_bf16 v[80:83], v[48:51], v[160:163], v[80:83]
    v_cvt_pk_bf16_f32 v10, v20, v21
    v_cvt_pk_bf16_f32 v11, v22, v23
    ds_write_b128 v4, v[8:11] offset:2048
    v_mfma_f32_16x16x32_bf16 v[84:87], v[48:51], v[164:167], v[84:87]
    v_bfe_u32 v16, v38, 12, 3
    v_bfe_u32 v17, v38, 15, 3
    v_mfma_f32_16x16x32_bf16 v[88:91], v[52:55], v[160:163], v[88:91]
    v_bfe_u32 v18, v38, 18, 3
    v_bfe_u32 v19, v38, 21, 3
    v_mfma_f32_16x16x32_bf16 v[92:95], v[52:55], v[164:167], v[92:95]
    v_cvt_f32_u32 v16, v16
    v_cvt_f32_u32 v17, v17
    v_cvt_f32_u32 v18, v18
    v_mfma_f32_16x16x32_bf16 v[96:99], v[56:59], v[160:163], v[96:99]
    v_cvt_f32_u32 v19, v19
    v_fma_f32 v16, v16, v46, -v47
    v_mfma_f32_16x16x32_bf16 v[100:103], v[56:59], v[164:167], v[100:103]
    v_fma_f32 v17, v17, v46, -v47
    v_fma_f32 v18, v18, v46, -v47
    v_mfma_f32_16x16x32_bf16 v[104:107], v[60:63], v[160:163], v[104:107]
    v_fma_f32 v19, v19, v46, -v47
    v_cvt_pk_bf16_f32 v12, v16, v17
    v_cvt_pk_bf16_f32 v13, v18, v19
    v_mfma_f32_16x16x32_bf16 v[108:111], v[60:63], v[164:167], v[108:111]
    v_bfe_u32 v20, v38, 24, 3
    v_bfe_u32 v21, v38, 27, 3
    s_waitcnt lgkmcnt(1)
    s_waitcnt vmcnt(20)
    ds_read_b128 v[48:51], v1 offset:32768
    ds_read_b128 v[52:55], v1 offset:33024
    ds_read_b128 v[56:59], v1 offset:33280
    ds_read_b128 v[60:63], v1 offset:33536
    v_mfma_f32_16x16x32_bf16 v[80:83], v[64:67], v[168:171], v[80:83]
    v_bfe_u32 v22, v39, 0, 3
    v_bfe_u32 v23, v39, 3, 3
    v_mfma_f32_16x16x32_bf16 v[84:87], v[64:67], v[172:175], v[84:87]
    v_cvt_f32_u32 v20, v20
    v_cvt_f32_u32 v21, v21
    v_cvt_f32_u32 v22, v22
    v_mfma_f32_16x16x32_bf16 v[88:91], v[68:71], v[168:171], v[88:91]
    v_cvt_f32_u32 v23, v23
    v_fma_f32 v20, v20, v46, -v47
    v_mfma_f32_16x16x32_bf16 v[92:95], v[68:71], v[172:175], v[92:95]
    v_fma_f32 v21, v21, v46, -v47
    v_fma_f32 v22, v22, v46, -v47
    v_mfma_f32_16x16x32_bf16 v[96:99], v[72:75], v[168:171], v[96:99]
    v_fma_f32 v23, v23, v46, -v47
    v_cvt_pk_bf16_f32 v14, v20, v21
    v_cvt_pk_bf16_f32 v15, v22, v23
    v_mfma_f32_16x16x32_bf16 v[100:103], v[72:75], v[172:175], v[100:103]
    ds_write_b128 v4, v[12:15] offset:3072
    v_bfe_u32 v16, v39, 6, 3
    v_mfma_f32_16x16x32_bf16 v[104:107], v[76:79], v[168:171], v[104:107]
    v_bfe_u32 v17, v39, 9, 3
    v_bfe_u32 v18, v39, 12, 3
    v_mfma_f32_16x16x32_bf16 v[108:111], v[76:79], v[172:175], v[108:111]
    v_bfe_u32 v19, v39, 15, 3
    v_cvt_f32_u32 v16, v16
    v_cvt_f32_u32 v17, v17
    s_waitcnt lgkmcnt(1)
    s_waitcnt vmcnt(18)
    ds_read_b128 v[64:67], v2 offset:0
    ds_read_b128 v[68:71], v2 offset:256
    ds_read_b128 v[72:75], v2 offset:512
    ds_read_b128 v[76:79], v2 offset:768
    v_mfma_f32_16x16x32_bf16 v[80:83], v[48:51], v[176:179], v[80:83]
    v_cvt_f32_u32 v18, v18
    v_cvt_f32_u32 v19, v19
    v_mfma_f32_16x16x32_bf16 v[84:87], v[48:51], v[180:183], v[84:87]
    v_fma_f32 v16, v16, v46, -v47
    v_fma_f32 v17, v17, v46, -v47
    v_mfma_f32_16x16x32_bf16 v[88:91], v[52:55], v[176:179], v[88:91]
    v_fma_f32 v18, v18, v46, -v47
    v_fma_f32 v19, v19, v46, -v47
    v_cvt_pk_bf16_f32 v8, v16, v17
    v_mfma_f32_16x16x32_bf16 v[92:95], v[52:55], v[180:183], v[92:95]
    v_cvt_pk_bf16_f32 v9, v18, v19
    v_bfe_u32 v20, v39, 18, 3
    v_mfma_f32_16x16x32_bf16 v[96:99], v[56:59], v[176:179], v[96:99]
    v_bfe_u32 v21, v39, 21, 3
    v_bfe_u32 v22, v39, 24, 3
    v_mfma_f32_16x16x32_bf16 v[100:103], v[56:59], v[180:183], v[100:103]
    v_bfe_u32 v23, v39, 27, 3
    v_cvt_f32_u32 v20, v20
    v_cvt_f32_u32 v21, v21
    v_mfma_f32_16x16x32_bf16 v[104:107], v[60:63], v[176:179], v[104:107]
    v_cvt_f32_u32 v22, v22
    v_cvt_f32_u32 v23, v23
    v_mfma_f32_16x16x32_bf16 v[108:111], v[60:63], v[180:183], v[108:111]
    v_fma_f32 v20, v20, v46, -v47
    v_fma_f32 v21, v21, v46, -v47
    s_waitcnt lgkmcnt(0)
    s_waitcnt vmcnt(16)
    ds_read_b128 v[48:51], v2 offset:4096
    ds_read_b128 v[52:55], v2 offset:4352
    ds_read_b128 v[56:59], v2 offset:4608
    ds_read_b128 v[60:63], v2 offset:4864
    v_mfma_f32_16x16x32_bf16 v[80:83], v[64:67], v[184:187], v[80:83]
    v_fma_f32 v22, v22, v46, -v47
    v_fma_f32 v23, v23, v46, -v47
    v_cvt_pk_bf16_f32 v10, v20, v21
    v_mfma_f32_16x16x32_bf16 v[84:87], v[64:67], v[188:191], v[84:87]
    v_cvt_pk_bf16_f32 v11, v22, v23
    ds_write_b128 v4, v[8:11] offset:4096
    v_mfma_f32_16x16x32_bf16 v[88:91], v[68:71], v[184:187], v[88:91]
    v_bfe_u32 v16, v40, 0, 3
    v_bfe_u32 v17, v40, 3, 3
    v_bfe_u32 v18, v40, 6, 3
    v_mfma_f32_16x16x32_bf16 v[92:95], v[68:71], v[188:191], v[92:95]
    v_bfe_u32 v19, v40, 9, 3
    v_cvt_f32_u32 v16, v16
    v_mfma_f32_16x16x32_bf16 v[96:99], v[72:75], v[184:187], v[96:99]
    v_cvt_f32_u32 v17, v17
    v_cvt_f32_u32 v18, v18
    v_mfma_f32_16x16x32_bf16 v[100:103], v[72:75], v[188:191], v[100:103]
    v_cvt_f32_u32 v19, v19
    v_fma_f32 v16, v16, v46, -v47
    v_fma_f32 v17, v17, v46, -v47
    v_mfma_f32_16x16x32_bf16 v[104:107], v[76:79], v[184:187], v[104:107]
    v_fma_f32 v18, v18, v46, -v47
    v_fma_f32 v19, v19, v46, -v47
    v_mfma_f32_16x16x32_bf16 v[108:111], v[76:79], v[188:191], v[108:111]
    v_cvt_pk_bf16_f32 v12, v16, v17
    v_cvt_pk_bf16_f32 v13, v18, v19
    s_waitcnt lgkmcnt(1)
    s_waitcnt vmcnt(14)
    ds_read_b128 v[64:67], v2 offset:8192
    ds_read_b128 v[68:71], v2 offset:8448
    ds_read_b128 v[72:75], v2 offset:8704
    ds_read_b128 v[76:79], v2 offset:8960
    v_mfma_f32_16x16x32_bf16 v[80:83], v[48:51], v[192:195], v[80:83]
    v_bfe_u32 v20, v40, 12, 3
    v_bfe_u32 v21, v40, 15, 3
    v_bfe_u32 v22, v40, 18, 3
    v_mfma_f32_16x16x32_bf16 v[84:87], v[48:51], v[196:199], v[84:87]
    v_bfe_u32 v23, v40, 21, 3
    v_cvt_f32_u32 v20, v20
    v_mfma_f32_16x16x32_bf16 v[88:91], v[52:55], v[192:195], v[88:91]
    v_cvt_f32_u32 v21, v21
    v_cvt_f32_u32 v22, v22
    v_mfma_f32_16x16x32_bf16 v[92:95], v[52:55], v[196:199], v[92:95]
    v_cvt_f32_u32 v23, v23
    v_fma_f32 v20, v20, v46, -v47
    v_fma_f32 v21, v21, v46, -v47
    v_mfma_f32_16x16x32_bf16 v[96:99], v[56:59], v[192:195], v[96:99]
    v_fma_f32 v22, v22, v46, -v47
    v_fma_f32 v23, v23, v46, -v47
    v_mfma_f32_16x16x32_bf16 v[100:103], v[56:59], v[196:199], v[100:103]
    v_cvt_pk_bf16_f32 v14, v20, v21
    v_cvt_pk_bf16_f32 v15, v22, v23
    v_mfma_f32_16x16x32_bf16 v[104:107], v[60:63], v[192:195], v[104:107]
    ds_write_b128 v4, v[12:15] offset:5120
    v_bfe_u32 v16, v40, 24, 3
    v_bfe_u32 v17, v40, 27, 3
    v_mfma_f32_16x16x32_bf16 v[108:111], v[60:63], v[196:199], v[108:111]
    v_bfe_u32 v18, v41, 0, 3
    v_bfe_u32 v19, v41, 3, 3
    s_waitcnt lgkmcnt(1)
    s_waitcnt vmcnt(12)
    ds_read_b128 v[48:51], v2 offset:12288
    ds_read_b128 v[52:55], v2 offset:12544
    ds_read_b128 v[56:59], v2 offset:12800
    ds_read_b128 v[60:63], v2 offset:13056
    v_mfma_f32_16x16x32_bf16 v[80:83], v[64:67], v[200:203], v[80:83]
    v_cvt_f32_u32 v16, v16
    v_cvt_f32_u32 v17, v17
    v_mfma_f32_16x16x32_bf16 v[84:87], v[64:67], v[204:207], v[84:87]
    v_cvt_f32_u32 v18, v18
    v_cvt_f32_u32 v19, v19
    v_fma_f32 v16, v16, v46, -v47
    v_mfma_f32_16x16x32_bf16 v[88:91], v[68:71], v[200:203], v[88:91]
    v_fma_f32 v17, v17, v46, -v47
    v_fma_f32 v18, v18, v46, -v47
    v_mfma_f32_16x16x32_bf16 v[92:95], v[68:71], v[204:207], v[92:95]
    v_fma_f32 v19, v19, v46, -v47
    v_cvt_pk_bf16_f32 v8, v16, v17
    v_mfma_f32_16x16x32_bf16 v[96:99], v[72:75], v[200:203], v[96:99]
    v_cvt_pk_bf16_f32 v9, v18, v19
    v_bfe_u32 v20, v41, 6, 3
    v_bfe_u32 v21, v41, 9, 3
    v_mfma_f32_16x16x32_bf16 v[100:103], v[72:75], v[204:207], v[100:103]
    v_bfe_u32 v22, v41, 12, 3
    v_bfe_u32 v23, v41, 15, 3
    v_mfma_f32_16x16x32_bf16 v[104:107], v[76:79], v[200:203], v[104:107]
    v_cvt_f32_u32 v20, v20
    v_cvt_f32_u32 v21, v21
    v_mfma_f32_16x16x32_bf16 v[108:111], v[76:79], v[204:207], v[108:111]
    v_cvt_f32_u32 v22, v22
    v_cvt_f32_u32 v23, v23
    v_fma_f32 v20, v20, v46, -v47
    s_waitcnt lgkmcnt(0)
    s_waitcnt vmcnt(10)
    ds_read_b128 v[64:67], v2 offset:16384
    ds_read_b128 v[68:71], v2 offset:16640
    ds_read_b128 v[72:75], v2 offset:16896
    ds_read_b128 v[76:79], v2 offset:17152
    v_mfma_f32_16x16x32_bf16 v[80:83], v[48:51], v[208:211], v[80:83]
    v_fma_f32 v21, v21, v46, -v47
    v_fma_f32 v22, v22, v46, -v47
    v_mfma_f32_16x16x32_bf16 v[84:87], v[48:51], v[212:215], v[84:87]
    v_fma_f32 v23, v23, v46, -v47
    v_cvt_pk_bf16_f32 v10, v20, v21
    v_mfma_f32_16x16x32_bf16 v[88:91], v[52:55], v[208:211], v[88:91]
    v_cvt_pk_bf16_f32 v11, v22, v23
    ds_write_b128 v4, v[8:11] offset:6144
    v_bfe_u32 v16, v41, 18, 3
    v_mfma_f32_16x16x32_bf16 v[92:95], v[52:55], v[212:215], v[92:95]
    v_bfe_u32 v17, v41, 21, 3
    v_bfe_u32 v18, v41, 24, 3
    v_mfma_f32_16x16x32_bf16 v[96:99], v[56:59], v[208:211], v[96:99]
    v_bfe_u32 v19, v41, 27, 3
    v_cvt_f32_u32 v16, v16
    v_mfma_f32_16x16x32_bf16 v[100:103], v[56:59], v[212:215], v[100:103]
    v_cvt_f32_u32 v17, v17
    v_cvt_f32_u32 v18, v18
    v_cvt_f32_u32 v19, v19
    v_mfma_f32_16x16x32_bf16 v[104:107], v[60:63], v[208:211], v[104:107]
    v_fma_f32 v16, v16, v46, -v47
    v_fma_f32 v17, v17, v46, -v47
    v_mfma_f32_16x16x32_bf16 v[108:111], v[60:63], v[212:215], v[108:111]
    v_fma_f32 v18, v18, v46, -v47
    v_fma_f32 v19, v19, v46, -v47
    s_waitcnt lgkmcnt(1)
    s_waitcnt vmcnt(8)
    ds_read_b128 v[48:51], v2 offset:20480
    ds_read_b128 v[52:55], v2 offset:20736
    ds_read_b128 v[56:59], v2 offset:20992
    ds_read_b128 v[60:63], v2 offset:21248
    v_mfma_f32_16x16x32_bf16 v[80:83], v[64:67], v[216:219], v[80:83]
    v_cvt_pk_bf16_f32 v12, v16, v17
    v_cvt_pk_bf16_f32 v13, v18, v19
    v_bfe_u32 v20, v42, 0, 3
    v_mfma_f32_16x16x32_bf16 v[84:87], v[64:67], v[220:223], v[84:87]
    v_bfe_u32 v21, v42, 3, 3
    v_bfe_u32 v22, v42, 6, 3
    v_mfma_f32_16x16x32_bf16 v[88:91], v[68:71], v[216:219], v[88:91]
    v_bfe_u32 v23, v42, 9, 3
    v_cvt_f32_u32 v20, v20
    v_cvt_f32_u32 v21, v21
    v_mfma_f32_16x16x32_bf16 v[92:95], v[68:71], v[220:223], v[92:95]
    v_cvt_f32_u32 v22, v22
    v_cvt_f32_u32 v23, v23
    v_mfma_f32_16x16x32_bf16 v[96:99], v[72:75], v[216:219], v[96:99]
    v_fma_f32 v20, v20, v46, -v47
    v_fma_f32 v21, v21, v46, -v47
    v_mfma_f32_16x16x32_bf16 v[100:103], v[72:75], v[220:223], v[100:103]
    v_fma_f32 v22, v22, v46, -v47
    v_fma_f32 v23, v23, v46, -v47
    v_cvt_pk_bf16_f32 v14, v20, v21
    v_mfma_f32_16x16x32_bf16 v[104:107], v[76:79], v[216:219], v[104:107]
    v_cvt_pk_bf16_f32 v15, v22, v23
    ds_write_b128 v4, v[12:15] offset:7168
    v_mfma_f32_16x16x32_bf16 v[108:111], v[76:79], v[220:223], v[108:111]
    v_bfe_u32 v16, v42, 12, 3
    v_bfe_u32 v17, v42, 15, 3
    s_waitcnt lgkmcnt(1)
    s_waitcnt vmcnt(6)
    ds_read_b128 v[64:67], v2 offset:24576
    ds_read_b128 v[68:71], v2 offset:24832
    ds_read_b128 v[72:75], v2 offset:25088
    ds_read_b128 v[76:79], v2 offset:25344
    v_mfma_f32_16x16x32_bf16 v[80:83], v[48:51], v[224:227], v[80:83]
    v_bfe_u32 v18, v42, 18, 3
    v_bfe_u32 v19, v42, 21, 3
    v_cvt_f32_u32 v16, v16
    v_mfma_f32_16x16x32_bf16 v[84:87], v[48:51], v[228:231], v[84:87]
    v_cvt_f32_u32 v17, v17
    v_cvt_f32_u32 v18, v18
    v_mfma_f32_16x16x32_bf16 v[88:91], v[52:55], v[224:227], v[88:91]
    v_cvt_f32_u32 v19, v19
    v_fma_f32 v16, v16, v46, -v47
    v_mfma_f32_16x16x32_bf16 v[92:95], v[52:55], v[228:231], v[92:95]
    v_fma_f32 v17, v17, v46, -v47
    v_fma_f32 v18, v18, v46, -v47
    v_fma_f32 v19, v19, v46, -v47
    v_mfma_f32_16x16x32_bf16 v[96:99], v[56:59], v[224:227], v[96:99]
    v_cvt_pk_bf16_f32 v8, v16, v17
    v_cvt_pk_bf16_f32 v9, v18, v19
    v_mfma_f32_16x16x32_bf16 v[100:103], v[56:59], v[228:231], v[100:103]
    v_bfe_u32 v20, v42, 24, 3
    v_bfe_u32 v21, v42, 27, 3
    v_mfma_f32_16x16x32_bf16 v[104:107], v[60:63], v[224:227], v[104:107]
    v_bfe_u32 v22, v43, 0, 3
    v_bfe_u32 v23, v43, 3, 3
    v_cvt_f32_u32 v20, v20
    v_mfma_f32_16x16x32_bf16 v[108:111], v[60:63], v[228:231], v[108:111]
    v_cvt_f32_u32 v21, v21
    v_cvt_f32_u32 v22, v22
    s_waitcnt lgkmcnt(0)
    s_waitcnt vmcnt(4)
    ds_read_b128 v[48:51], v2 offset:28672
    ds_read_b128 v[52:55], v2 offset:28928
    ds_read_b128 v[56:59], v2 offset:29184
    ds_read_b128 v[60:63], v2 offset:29440
    v_mfma_f32_16x16x32_bf16 v[80:83], v[64:67], v[232:235], v[80:83]
    v_cvt_f32_u32 v23, v23
    v_fma_f32 v20, v20, v46, -v47
    v_mfma_f32_16x16x32_bf16 v[84:87], v[64:67], v[236:239], v[84:87]
    v_fma_f32 v21, v21, v46, -v47
    v_fma_f32 v22, v22, v46, -v47
    v_fma_f32 v23, v23, v46, -v47
    v_mfma_f32_16x16x32_bf16 v[88:91], v[68:71], v[232:235], v[88:91]
    v_cvt_pk_bf16_f32 v10, v20, v21
    v_cvt_pk_bf16_f32 v11, v22, v23
    v_mfma_f32_16x16x32_bf16 v[92:95], v[68:71], v[236:239], v[92:95]
    ds_write_b128 v4, v[8:11] offset:8192
    v_bfe_u32 v16, v43, 6, 3
    v_mfma_f32_16x16x32_bf16 v[96:99], v[72:75], v[232:235], v[96:99]
    v_bfe_u32 v17, v43, 9, 3
    v_bfe_u32 v18, v43, 12, 3
    v_bfe_u32 v19, v43, 15, 3
    v_mfma_f32_16x16x32_bf16 v[100:103], v[72:75], v[236:239], v[100:103]
    v_cvt_f32_u32 v16, v16
    v_cvt_f32_u32 v17, v17
    v_mfma_f32_16x16x32_bf16 v[104:107], v[76:79], v[232:235], v[104:107]
    v_cvt_f32_u32 v18, v18
    v_cvt_f32_u32 v19, v19
    v_mfma_f32_16x16x32_bf16 v[108:111], v[76:79], v[236:239], v[108:111]
    v_fma_f32 v16, v16, v46, -v47
    v_fma_f32 v17, v17, v46, -v47
    v_fma_f32 v18, v18, v46, -v47
    s_waitcnt lgkmcnt(1)
    s_waitcnt vmcnt(2)
    ds_read_b128 v[64:67], v2 offset:32768
    ds_read_b128 v[68:71], v2 offset:33024
    ds_read_b128 v[72:75], v2 offset:33280
    ds_read_b128 v[76:79], v2 offset:33536
    v_mfma_f32_16x16x32_bf16 v[80:83], v[48:51], v[240:243], v[80:83]
    v_fma_f32 v19, v19, v46, -v47
    v_cvt_pk_bf16_f32 v12, v16, v17
    v_mfma_f32_16x16x32_bf16 v[84:87], v[48:51], v[244:247], v[84:87]
    v_cvt_pk_bf16_f32 v13, v18, v19
    v_bfe_u32 v20, v43, 18, 3
    v_mfma_f32_16x16x32_bf16 v[88:91], v[52:55], v[240:243], v[88:91]
    v_bfe_u32 v21, v43, 21, 3
    v_bfe_u32 v22, v43, 24, 3
    v_bfe_u32 v23, v43, 27, 3
    v_mfma_f32_16x16x32_bf16 v[92:95], v[52:55], v[244:247], v[92:95]
    v_cvt_f32_u32 v20, v20
    v_cvt_f32_u32 v21, v21
    v_mfma_f32_16x16x32_bf16 v[96:99], v[56:59], v[240:243], v[96:99]
    v_cvt_f32_u32 v22, v22
    v_cvt_f32_u32 v23, v23
    v_mfma_f32_16x16x32_bf16 v[100:103], v[56:59], v[244:247], v[100:103]
    v_fma_f32 v20, v20, v46, -v47
    v_fma_f32 v21, v21, v46, -v47
    v_fma_f32 v22, v22, v46, -v47
    v_mfma_f32_16x16x32_bf16 v[104:107], v[60:63], v[240:243], v[104:107]
    v_fma_f32 v23, v23, v46, -v47
    v_cvt_pk_bf16_f32 v14, v20, v21
    v_mfma_f32_16x16x32_bf16 v[108:111], v[60:63], v[244:247], v[108:111]
    v_cvt_pk_bf16_f32 v15, v22, v23
    ds_write_b128 v4, v[12:15] offset:9216
    s_waitcnt lgkmcnt(1)
    s_waitcnt vmcnt(0)
    v_and_b32 v16, 63, v0
    v_cmp_gt_u32 vcc, 48, v16
    s_nop 1
    v_cndmask_b32 v249, 0, v249, vcc
    v_cndmask_b32 v250, 0, v250, vcc
    v_cndmask_b32 v251, 0, v251, vcc
    v_cndmask_b32 v253, 0, v253, vcc
    v_cndmask_b32 v254, 0, v254, vcc
    v_cndmask_b32 v255, 0, v255, vcc
    s_nop 1
    v_mfma_f32_16x16x32_bf16 v[80:83], v[64:67], v[248:251], v[80:83]
    v_mfma_f32_16x16x32_bf16 v[84:87], v[64:67], v[252:255], v[84:87]
    v_mfma_f32_16x16x32_bf16 v[88:91], v[68:71], v[248:251], v[88:91]
    v_mfma_f32_16x16x32_bf16 v[92:95], v[68:71], v[252:255], v[92:95]
    v_mfma_f32_16x16x32_bf16 v[96:99], v[72:75], v[248:251], v[96:99]
    v_mfma_f32_16x16x32_bf16 v[100:103], v[72:75], v[252:255], v[100:103]
    v_mfma_f32_16x16x32_bf16 v[104:107], v[76:79], v[248:251], v[104:107]
    v_mfma_f32_16x16x32_bf16 v[108:111], v[76:79], v[252:255], v[108:111]
    s_nop 7
    s_nop 1
    v_cvt_pk_bf16_f32 v8, v80, v81
    v_cvt_pk_bf16_f32 v9, v82, v83
    v_cvt_pk_bf16_f32 v10, v88, v89
    v_cvt_pk_bf16_f32 v11, v90, v91
    buffer_store_dwordx4 v[8:11], v6, s[32:35], 0 offen offset:0
    v_cvt_pk_bf16_f32 v12, v96, v97
    v_cvt_pk_bf16_f32 v13, v98, v99
    v_cvt_pk_bf16_f32 v14, v104, v105
    v_cvt_pk_bf16_f32 v15, v106, v107
    buffer_store_dwordx4 v[12:15], v6, s[32:35], 0 offen offset:64
    v_cvt_pk_bf16_f32 v16, v84, v85
    v_cvt_pk_bf16_f32 v17, v86, v87
    v_cvt_pk_bf16_f32 v18, v92, v93
    v_cvt_pk_bf16_f32 v19, v94, v95
    buffer_store_dwordx4 v[16:19], v6, s[32:35], s37 offen offset:0
    v_cvt_pk_bf16_f32 v20, v100, v101
    v_cvt_pk_bf16_f32 v21, v102, v103
    v_cvt_pk_bf16_f32 v22, v108, v109
    v_cvt_pk_bf16_f32 v23, v110, v111
    buffer_store_dwordx4 v[20:23], v6, s[32:35], s37 offen offset:64
    s_waitcnt lgkmcnt(0)
    s_barrier
    s_cmp_ge_u32 s46, 2
    s_cbranch_scc1 L_P1_NODQ
    v_and_b32 v16, 15, v0
    v_lshrrev_b32 v17, 4, v0
    v_add_u32 v18, s48, v16
    v_add_u32 v18, 128, v18
    v_lshlrev_b32 v7, 1, v18
    v_mul_u32_u24 v19, 36864, v17
    v_add_u32 v19, v19, v18
    v_lshlrev_b32 v5, 2, v19
    v_mul_u32_u24 v19, 10240, v17
    v_lshl_add_u32 v4, v16, 4, v19
    buffer_load_ushort v32, v7, s[24:27], 0 offen offset:0
    buffer_load_ushort v33, v7, s[28:31], 0 offen offset:0
    buffer_load_dword v24, v5, s[20:23], 0 offen offset:0
    buffer_load_dword v25, v5, s[20:23], s38 offen offset:0
    buffer_load_dword v26, v5, s[20:23], s39 offen offset:0
    buffer_load_dword v27, v5, s[20:23], s40 offen offset:0
    buffer_load_dword v28, v5, s[20:23], s41 offen offset:0
    buffer_load_dword v29, v5, s[20:23], s42 offen offset:0
    buffer_load_dword v30, v5, s[20:23], s43 offen offset:0
    buffer_load_dword v31, v5, s[20:23], s44 offen offset:0
    v_add_u32 v1, 81920, v3
    v_add_u32 v2, 118784, v3
    ds_read_b128 v[48:51], v1 offset:0
    ds_read_b128 v[52:55], v1 offset:256
    ds_read_b128 v[56:59], v1 offset:512
    ds_read_b128 v[60:63], v1 offset:768
    s_waitcnt lgkmcnt(0)
    ds_read_b128 v[64:67], v1 offset:4096
    ds_read_b128 v[68:71], v1 offset:4352
    ds_read_b128 v[72:75], v1 offset:4608
    ds_read_b128 v[76:79], v1 offset:4864
    v_mfma_f32_16x16x32_bf16 v[80:83], v[48:51], v[112:115], 0
    v_mfma_f32_16x16x32_bf16 v[84:87], v[48:51], v[116:119], 0
    v_mfma_f32_16x16x32_bf16 v[88:91], v[52:55], v[112:115], 0
    v_mfma_f32_16x16x32_bf16 v[92:95], v[52:55], v[116:119], 0
    v_mfma_f32_16x16x32_bf16 v[96:99], v[56:59], v[112:115], 0
    v_mfma_f32_16x16x32_bf16 v[100:103], v[56:59], v[116:119], 0
    v_mfma_f32_16x16x32_bf16 v[104:107], v[60:63], v[112:115], 0
    v_mfma_f32_16x16x32_bf16 v[108:111], v[60:63], v[116:119], 0
    s_waitcnt lgkmcnt(0)
    ds_read_b128 v[48:51], v1 offset:8192
    ds_read_b128 v[52:55], v1 offset:8448
    ds_read_b128 v[56:59], v1 offset:8704
    ds_read_b128 v[60:63], v1 offset:8960
    v_mfma_f32_16x16x32_bf16 v[80:83], v[64:67], v[120:123], v[80:83]
    s_waitcnt vmcnt(0)
    v_lshlrev_b32 v32, 16, v32
    v_lshlrev_b32 v33, 16, v33
    v_mfma_f32_16x16x32_bf16 v[84:87], v[64:67], v[124:127], v[84:87]
    v_mul_f32 v33, v33, v32
    v_lshrrev_b32 v16, 4, v0
    v_mfma_f32_16x16x32_bf16 v[88:91], v[68:71], v[120:123], v[88:91]
    v_cmp_ne_u32 vcc, 7, v16
    s_nop 1
    v_cndmask_b32 v34, 0, v32, vcc
    v_mfma_f32_16x16x32_bf16 v[92:95], v[68:71], v[124:127], v[92:95]
    v_cndmask_b32 v35, 0, v33, vcc
    v_bfe_u32 v16, v24, 0, 3
    v_mfma_f32_16x16x32_bf16 v[96:99], v[72:75], v[120:123], v[96:99]
    v_bfe_u32 v17, v24, 3, 3
    v_bfe_u32 v18, v24, 6, 3
    v_mfma_f32_16x16x32_bf16 v[100:103], v[72:75], v[124:127], v[100:103]
    v_bfe_u32 v19, v24, 9, 3
    v_cvt_f32_u32 v16, v16
    v_cvt_f32_u32 v17, v17
    v_mfma_f32_16x16x32_bf16 v[104:107], v[76:79], v[120:123], v[104:107]
    v_cvt_f32_u32 v18, v18
    v_cvt_f32_u32 v19, v19
    v_mfma_f32_16x16x32_bf16 v[108:111], v[76:79], v[124:127], v[108:111]
    v_fma_f32 v16, v16, v32, -v33
    v_fma_f32 v17, v17, v32, -v33
    s_waitcnt lgkmcnt(0)
    ds_read_b128 v[64:67], v1 offset:12288
    ds_read_b128 v[68:71], v1 offset:12544
    ds_read_b128 v[72:75], v1 offset:12800
    ds_read_b128 v[76:79], v1 offset:13056
    v_mfma_f32_16x16x32_bf16 v[80:83], v[48:51], v[128:131], v[80:83]
    v_fma_f32 v18, v18, v32, -v33
    v_fma_f32 v19, v19, v32, -v33
    v_cvt_pk_bf16_f32 v8, v16, v17
    v_mfma_f32_16x16x32_bf16 v[84:87], v[48:51], v[132:135], v[84:87]
    v_cvt_pk_bf16_f32 v9, v18, v19
    v_bfe_u32 v20, v24, 12, 3
    v_mfma_f32_16x16x32_bf16 v[88:91], v[52:55], v[128:131], v[88:91]
    v_bfe_u32 v21, v24, 15, 3
    v_bfe_u32 v22, v24, 18, 3
    v_mfma_f32_16x16x32_bf16 v[92:95], v[52:55], v[132:135], v[92:95]
    v_bfe_u32 v23, v24, 21, 3
    v_cvt_f32_u32 v20, v20
    v_cvt_f32_u32 v21, v21
    v_mfma_f32_16x16x32_bf16 v[96:99], v[56:59], v[128:131], v[96:99]
    v_cvt_f32_u32 v22, v22
    v_cvt_f32_u32 v23, v23
    v_mfma_f32_16x16x32_bf16 v[100:103], v[56:59], v[132:135], v[100:103]
    v_fma_f32 v20, v20, v32, -v33
    v_fma_f32 v21, v21, v32, -v33
    v_mfma_f32_16x16x32_bf16 v[104:107], v[60:63], v[128:131], v[104:107]
    v_fma_f32 v22, v22, v32, -v33
    v_fma_f32 v23, v23, v32, -v33
    v_cvt_pk_bf16_f32 v10, v20, v21
    v_mfma_f32_16x16x32_bf16 v[108:111], v[60:63], v[132:135], v[108:111]
    v_cvt_pk_bf16_f32 v11, v22, v23
    ds_write_b128 v4, v[8:11] offset:0
    s_waitcnt lgkmcnt(1)
    ds_read_b128 v[48:51], v1 offset:16384
    ds_read_b128 v[52:55], v1 offset:16640
    ds_read_b128 v[56:59], v1 offset:16896
    ds_read_b128 v[60:63], v1 offset:17152
    v_mfma_f32_16x16x32_bf16 v[80:83], v[64:67], v[136:139], v[80:83]
    v_bfe_u32 v16, v24, 24, 3
    v_bfe_u32 v17, v24, 27, 3
    v_mfma_f32_16x16x32_bf16 v[84:87], v[64:67], v[140:143], v[84:87]
    v_bfe_u32 v18, v25, 0, 3
    v_bfe_u32 v19, v25, 3, 3
    v_cvt_f32_u32 v16, v16
    v_mfma_f32_16x16x32_bf16 v[88:91], v[68:71], v[136:139], v[88:91]
    v_cvt_f32_u32 v17, v17
    v_cvt_f32_u32 v18, v18
    v_mfma_f32_16x16x32_bf16 v[92:95], v[68:71], v[140:143], v[92:95]
    v_cvt_f32_u32 v19, v19
    v_fma_f32 v16, v16, v32, -v33
    v_mfma_f32_16x16x32_bf16 v[96:99], v[72:75], v[136:139], v[96:99]
    v_fma_f32 v17, v17, v32, -v33
    v_fma_f32 v18, v18, v34, -v35
    v_fma_f32 v19, v19, v34, -v35
    v_mfma_f32_16x16x32_bf16 v[100:103], v[72:75], v[140:143], v[100:103]
    v_cvt_pk_bf16_f32 v12, v16, v17
    v_cvt_pk_bf16_f32 v13, v18, v19
    v_mfma_f32_16x16x32_bf16 v[104:107], v[76:79], v[136:139], v[104:107]
    v_bfe_u32 v20, v25, 6, 3
    v_bfe_u32 v21, v25, 9, 3
    v_mfma_f32_16x16x32_bf16 v[108:111], v[76:79], v[140:143], v[108:111]
    v_bfe_u32 v22, v25, 12, 3
    v_bfe_u32 v23, v25, 15, 3
    v_cvt_f32_u32 v20, v20
    s_waitcnt lgkmcnt(0)
    ds_read_b128 v[64:67], v1 offset:20480
    ds_read_b128 v[68:71], v1 offset:20736
    ds_read_b128 v[72:75], v1 offset:20992
    ds_read_b128 v[76:79], v1 offset:21248
    v_mfma_f32_16x16x32_bf16 v[80:83], v[48:51], v[144:147], v[80:83]
    v_cvt_f32_u32 v21, v21
    v_cvt_f32_u32 v22, v22
    v_mfma_f32_16x16x32_bf16 v[84:87], v[48:51], v[148:151], v[84:87]
    v_cvt_f32_u32 v23, v23
    v_fma_f32 v20, v20, v34, -v35
    v_mfma_f32_16x16x32_bf16 v[88:91], v[52:55], v[144:147], v[88:91]
    v_fma_f32 v21, v21, v34, -v35
    v_fma_f32 v22, v22, v34, -v35
    v_fma_f32 v23, v23, v34, -v35
    v_mfma_f32_16x16x32_bf16 v[92:95], v[52:55], v[148:151], v[92:95]
    v_cvt_pk_bf16_f32 v14, v20, v21
    v_cvt_pk_bf16_f32 v15, v22, v23
    v_mfma_f32_16x16x32_bf16 v[96:99], v[56:59], v[144:147], v[96:99]
    ds_write_b128 v4, v[12:15] offset:1024
    v_bfe_u32 v16, v25, 18, 3
    v_mfma_f32_16x16x32_bf16 v[100:103], v[56:59], v[148:151], v[100:103]
    v_bfe_u32 v17, v25, 21, 3
    v_bfe_u32 v18, v25, 24, 3
    v_bfe_u32 v19, v25, 27, 3
    v_mfma_f32_16x16x32_bf16 v[104:107], v[60:63], v[144:147], v[104:107]
    v_cvt_f32_u32 v16, v16
    v_cvt_f32_u32 v17, v17
    v_mfma_f32_16x16x32_bf16 v[108:111], v[60:63], v[148:151], v[108:111]
    v_cvt_f32_u32 v18, v18
    v_cvt_f32_u32 v19, v19
    s_waitcnt lgkmcnt(1)
    ds_read_b128 v[48:51], v1 offset:24576
    ds_read_b128 v[52:55], v1 offset:24832
    ds_read_b128 v[56:59], v1 offset:25088
    ds_read_b128 v[60:63], v1 offset:25344
    v_mfma_f32_16x16x32_bf16 v[80:83], v[64:67], v[152:155], v[80:83]
    v_fma_f32 v16, v16, v34, -v35
    v_fma_f32 v17, v17, v34, -v35
    v_fma_f32 v18, v18, v34, -v35
    v_mfma_f32_16x16x32_bf16 v[84:87], v[64:67], v[156:159], v[84:87]
    v_fma_f32 v19, v19, v34, -v35
    v_cvt_pk_bf16_f32 v8, v16, v17
    v_mfma_f32_16x16x32_bf16 v[88:91], v[68:71], v[152:155], v[88:91]
    v_cvt_pk_bf16_f32 v9, v18, v19
    v_bfe_u32 v20, v26, 0, 3
    v_mfma_f32_16x16x32_bf16 v[92:95], v[68:71], v[156:159], v[92:95]
    v_bfe_u32 v21, v26, 3, 3
    v_bfe_u32 v22, v26, 6, 3
    v_bfe_u32 v23, v26, 9, 3
    v_mfma_f32_16x16x32_bf16 v[96:99], v[72:75], v[152:155], v[96:99]
    v_cvt_f32_u32 v20, v20
    v_cvt_f32_u32 v21, v21
    v_mfma_f32_16x16x32_bf16 v[100:103], v[72:75], v[156:159], v[100:103]
    v_cvt_f32_u32 v22, v22
    v_cvt_f32_u32 v23, v23
    v_mfma_f32_16x16x32_bf16 v[104:107], v[76:79], v[152:155], v[104:107]
    v_fma_f32 v20, v20, v34, -v35
    v_fma_f32 v21, v21, v34, -v35
    v_fma_f32 v22, v22, v34, -v35
    v_mfma_f32_16x16x32_bf16 v[108:111], v[76:79], v[156:159], v[108:111]
    v_fma_f32 v23, v23, v34, -v35
    v_cvt_pk_bf16_f32 v10, v20, v21
    s_waitcnt lgkmcnt(0)
    ds_read_b128 v[64:67], v1 offset:28672
    ds_read_b128 v[68:71], v1 offset:28928
    ds_read_b128 v[72:75], v1 offset:29184
    ds_read_b128 v[76:79], v1 offset:29440
    v_mfma_f32_16x16x32_bf16 v[80:83], v[48:51], v[160:163], v[80:83]
    v_cvt_pk_bf16_f32 v11, v22, v23
    ds_write_b128 v4, v[8:11] offset:2048
    v_mfma_f32_16x16x32_bf16 v[84:87], v[48:51], v[164:167], v[84:87]
    v_bfe_u32 v16, v26, 12, 3
    v_bfe_u32 v17, v26, 15, 3
    v_bfe_u32 v18, v26, 18, 3
    v_mfma_f32_16x16x32_bf16 v[88:91], v[52:55], v[160:163], v[88:91]
    v_bfe_u32 v19, v26, 21, 3
    v_cvt_f32_u32 v16, v16
    v_mfma_f32_16x16x32_bf16 v[92:95], v[52:55], v[164:167], v[92:95]
    v_cvt_f32_u32 v17, v17
    v_cvt_f32_u32 v18, v18
    v_mfma_f32_16x16x32_bf16 v[96:99], v[56:59], v[160:163], v[96:99]
    v_cvt_f32_u32 v19, v19
    v_fma_f32 v16, v16, v34, -v35
    v_fma_f32 v17, v17, v34, -v35
    v_mfma_f32_16x16x32_bf16 v[100:103], v[56:59], v[164:167], v[100:103]
    v_fma_f32 v18, v18, v34, -v35
    v_fma_f32 v19, v19, v34, -v35
    v_mfma_f32_16x16x32_bf16 v[104:107], v[60:63], v[160:163], v[104:107]
    v_cvt_pk_bf16_f32 v12, v16, v17
    v_cvt_pk_bf16_f32 v13, v18, v19
    v_mfma_f32_16x16x32_bf16 v[108:111], v[60:63], v[164:167], v[108:111]
    v_bfe_u32 v20, v26, 24, 3
    v_bfe_u32 v21, v26, 27, 3
    v_bfe_u32 v22, v27, 0, 3
    s_waitcnt lgkmcnt(1)
    ds_read_b128 v[48:51], v1 offset:32768
    ds_read_b128 v[52:55], v1 offset:33024
    ds_read_b128 v[56:59], v1 offset:33280
    ds_read_b128 v[60:63], v1 offset:33536
    v_mfma_f32_16x16x32_bf16 v[80:83], v[64:67], v[168:171], v[80:83]
    v_bfe_u32 v23, v27, 3, 3
    v_cvt_f32_u32 v20, v20
    v_mfma_f32_16x16x32_bf16 v[84:87], v[64:67], v[172:175], v[84:87]
    v_cvt_f32_u32 v21, v21
    v_cvt_f32_u32 v22, v22
    v_mfma_f32_16x16x32_bf16 v[88:91], v[68:71], v[168:171], v[88:91]
    v_cvt_f32_u32 v23, v23
    v_fma_f32 v20, v20, v34, -v35
    v_fma_f32 v21, v21, v34, -v35
    v_mfma_f32_16x16x32_bf16 v[92:95], v[68:71], v[172:175], v[92:95]
    v_fma_f32 v22, v22, v34, -v35
    v_fma_f32 v23, v23, v34, -v35
    v_mfma_f32_16x16x32_bf16 v[96:99], v[72:75], v[168:171], v[96:99]
    v_cvt_pk_bf16_f32 v14, v20, v21
    v_cvt_pk_bf16_f32 v15, v22, v23
    v_mfma_f32_16x16x32_bf16 v[100:103], v[72:75], v[172:175], v[100:103]
    ds_write_b128 v4, v[12:15] offset:3072
    v_bfe_u32 v16, v27, 6, 3
    v_bfe_u32 v17, v27, 9, 3
    v_mfma_f32_16x16x32_bf16 v[104:107], v[76:79], v[168:171], v[104:107]
    v_bfe_u32 v18, v27, 12, 3
    v_bfe_u32 v19, v27, 15, 3
    v_mfma_f32_16x16x32_bf16 v[108:111], v[76:79], v[172:175], v[108:111]
    v_cvt_f32_u32 v16, v16
    v_cvt_f32_u32 v17, v17
    s_waitcnt lgkmcnt(1)
    ds_read_b128 v[64:67], v2 offset:0
    ds_read_b128 v[68:71], v2 offset:256
    ds_read_b128 v[72:75], v2 offset:512
    ds_read_b128 v[76:79], v2 offset:768
    v_mfma_f32_16x16x32_bf16 v[80:83], v[48:51], v[176:179], v[80:83]
    v_cvt_f32_u32 v18, v18
    v_cvt_f32_u32 v19, v19
    v_fma_f32 v16, v16, v34, -v35
    v_mfma_f32_16x16x32_bf16 v[84:87], v[48:51], v[180:183], v[84:87]
    v_fma_f32 v17, v17, v34, -v35
    v_fma_f32 v18, v18, v34, -v35
    v_mfma_f32_16x16x32_bf16 v[88:91], v[52:55], v[176:179], v[88:91]
    v_fma_f32 v19, v19, v34, -v35
    v_cvt_pk_bf16_f32 v8, v16, v17
    v_mfma_f32_16x16x32_bf16 v[92:95], v[52:55], v[180:183], v[92:95]
    v_cvt_pk_bf16_f32 v9, v18, v19
    v_bfe_u32 v20, v27, 18, 3
    v_bfe_u32 v21, v27, 21, 3
    v_mfma_f32_16x16x32_bf16 v[96:99], v[56:59], v[176:179], v[96:99]
    v_bfe_u32 v22, v27, 24, 3
    v_bfe_u32 v23, v27, 27, 3
    v_mfma_f32_16x16x32_bf16 v[100:103], v[56:59], v[180:183], v[100:103]
    v_cvt_f32_u32 v20, v20
    v_cvt_f32_u32 v21, v21
    v_mfma_f32_16x16x32_bf16 v[104:107], v[60:63], v[176:179], v[104:107]
    v_cvt_f32_u32 v22, v22
    v_cvt_f32_u32 v23, v23
    v_fma_f32 v20, v20, v34, -v35
    v_mfma_f32_16x16x32_bf16 v[108:111], v[60:63], v[180:183], v[108:111]
    v_fma_f32 v21, v21, v34, -v35
    v_fma_f32 v22, v22, v34, -v35
    s_waitcnt lgkmcnt(0)
    ds_read_b128 v[48:51], v2 offset:4096
    ds_read_b128 v[52:55], v2 offset:4352
    ds_read_b128 v[56:59], v2 offset:4608
    ds_read_b128 v[60:63], v2 offset:4864
    v_mfma_f32_16x16x32_bf16 v[80:83], v[64:67], v[184:187], v[80:83]
    v_fma_f32 v23, v23, v34, -v35
    v_cvt_pk_bf16_f32 v10, v20, v21
    v_mfma_f32_16x16x32_bf16 v[84:87], v[64:67], v[188:191], v[84:87]
    v_cvt_pk_bf16_f32 v11, v22, v23
    ds_write_b128 v4, v[8:11] offset:4096
    v_bfe_u32 v16, v28, 0, 3
    v_mfma_f32_16x16x32_bf16 v[88:91], v[68:71], v[184:187], v[88:91]
    v_bfe_u32 v17, v28, 3, 3
    v_bfe_u32 v18, v28, 6, 3
    v_mfma_f32_16x16x32_bf16 v[92:95], v[68:71], v[188:191], v[92:95]
    v_bfe_u32 v19, v28, 9, 3
    v_cvt_f32_u32 v16, v16
    v_mfma_f32_16x16x32_bf16 v[96:99], v[72:75], v[184:187], v[96:99]
    v_cvt_f32_u32 v17, v17
    v_cvt_f32_u32 v18, v18
    v_cvt_f32_u32 v19, v19
    v_mfma_f32_16x16x32_bf16 v[100:103], v[72:75], v[188:191], v[100:103]
    v_fma_f32 v16, v16, v34, -v35
    v_fma_f32 v17, v17, v34, -v35
    v_mfma_f32_16x16x32_bf16 v[104:107], v[76:79], v[184:187], v[104:107]
    v_fma_f32 v18, v18, v34, -v35
    v_fma_f32 v19, v19, v34, -v35
    v_mfma_f32_16x16x32_bf16 v[108:111], v[76:79], v[188:191], v[108:111]
    v_cvt_pk_bf16_f32 v12, v16, v17
    v_cvt_pk_bf16_f32 v13, v18, v19
    v_bfe_u32 v20, v28, 12, 3
    s_waitcnt lgkmcnt(1)
    ds_read_b128 v[64:67], v2 offset:8192
    ds_read_b128 v[68:71], v2 offset:8448
    ds_read_b128 v[72:75], v2 offset:8704
    ds_read_b128 v[76:79], v2 offset:8960
    v_mfma_f32_16x16x32_bf16 v[80:83], v[48:51], v[192:195], v[80:83]
    v_bfe_u32 v21, v28, 15, 3
    v_bfe_u32 v22, v28, 18, 3
    v_mfma_f32_16x16x32_bf16 v[84:87], v[48:51], v[196:199], v[84:87]
    v_bfe_u32 v23, v28, 21, 3
    v_cvt_f32_u32 v20, v20
    v_mfma_f32_16x16x32_bf16 v[88:91], v[52:55], v[192:195], v[88:91]
    v_cvt_f32_u32 v21, v21
    v_cvt_f32_u32 v22, v22
    v_cvt_f32_u32 v23, v23
    v_mfma_f32_16x16x32_bf16 v[92:95], v[52:55], v[196:199], v[92:95]
    v_fma_f32 v20, v20, v34, -v35
    v_fma_f32 v21, v21, v34, -v35
    v_mfma_f32_16x16x32_bf16 v[96:99], v[56:59], v[192:195], v[96:99]
    v_fma_f32 v22, v22, v34, -v35
    v_fma_f32 v23, v23, v34, -v35
    v_mfma_f32_16x16x32_bf16 v[100:103], v[56:59], v[196:199], v[100:103]
    v_cvt_pk_bf16_f32 v14, v20, v21
    v_cvt_pk_bf16_f32 v15, v22, v23
    ds_write_b128 v4, v[12:15] offset:5120
    v_mfma_f32_16x16x32_bf16 v[104:107], v[60:63], v[192:195], v[104:107]
    v_bfe_u32 v16, v28, 24, 3
    v_bfe_u32 v17, v28, 27, 3
    v_mfma_f32_16x16x32_bf16 v[108:111], v[60:63], v[196:199], v[108:111]
    v_bfe_u32 v18, v29, 0, 3
    v_bfe_u32 v19, v29, 3, 3
    s_waitcnt lgkmcnt(1)
    ds_read_b128 v[48:51], v2 offset:12288
    ds_read_b128 v[52:55], v2 offset:12544
    ds_read_b128 v[56:59], v2 offset:12800
    ds_read_b128 v[60:63], v2 offset:13056
    v_mfma_f32_16x16x32_bf16 v[80:83], v[64:67], v[200:203], v[80:83]
    v_cvt_f32_u32 v16, v16
    v_cvt_f32_u32 v17, v17
    v_cvt_f32_u32 v18, v18
    v_mfma_f32_16x16x32_bf16 v[84:87], v[64:67], v[204:207], v[84:87]
    v_cvt_f32_u32 v19, v19
    v_fma_f32 v16, v16, v34, -v35
    v_mfma_f32_16x16x32_bf16 v[88:91], v[68:71], v[200:203], v[88:91]
    v_fma_f32 v17, v17, v34, -v35
    v_fma_f32 v18, v18, v34, -v35
    v_mfma_f32_16x16x32_bf16 v[92:95], v[68:71], v[204:207], v[92:95]
    v_fma_f32 v19, v19, v34, -v35
    v_cvt_pk_bf16_f32 v8, v16, v17
    v_cvt_pk_bf16_f32 v9, v18, v19
    v_mfma_f32_16x16x32_bf16 v[96:99], v[72:75], v[200:203], v[96:99]
    v_bfe_u32 v20, v29, 6, 3
    v_bfe_u32 v21, v29, 9, 3
    v_mfma_f32_16x16x32_bf16 v[100:103], v[72:75], v[204:207], v[100:103]
    v_bfe_u32 v22, v29, 12, 3
    v_bfe_u32 v23, v29, 15, 3
    v_mfma_f32_16x16x32_bf16 v[104:107], v[76:79], v[200:203], v[104:107]
    v_cvt_f32_u32 v20, v20
    v_cvt_f32_u32 v21, v21
    v_cvt_f32_u32 v22, v22
    v_mfma_f32_16x16x32_bf16 v[108:111], v[76:79], v[204:207], v[108:111]
    v_cvt_f32_u32 v23, v23
    v_fma_f32 v20, v20, v34, -v35
    s_waitcnt lgkmcnt(0)
    ds_read_b128 v[64:67], v2 offset:16384
    ds_read_b128 v[68:71], v2 offset:16640
    ds_read_b128 v[72:75], v2 offset:16896
    ds_read_b128 v[76:79], v2 offset:17152
    v_mfma_f32_16x16x32_bf16 v[80:83], v[48:51], v[208:211], v[80:83]
    v_fma_f32 v21, v21, v34, -v35
    v_fma_f32 v22, v22, v34, -v35
    v_mfma_f32_16x16x32_bf16 v[84:87], v[48:51], v[212:215], v[84:87]
    v_fma_f32 v23, v23, v34, -v35
    v_cvt_pk_bf16_f32 v10, v20, v21
    v_cvt_pk_bf16_f32 v11, v22, v23
    v_mfma_f32_16x16x32_bf16 v[88:91], v[52:55], v[208:211], v[88:91]
    ds_write_b128 v4, v[8:11] offset:6144
    v_bfe_u32 v16, v29, 18, 3
    v_mfma_f32_16x16x32_bf16 v[92:95], v[52:55], v[212:215], v[92:95]
    v_bfe_u32 v17, v29, 21, 3
    v_bfe_u32 v18, v29, 24, 3
    v_mfma_f32_16x16x32_bf16 v[96:99], v[56:59], v[208:211], v[96:99]
    v_bfe_u32 v19, v29, 27, 3
    v_cvt_f32_u32 v16, v16
    v_cvt_f32_u32 v17, v17
    v_mfma_f32_16x16x32_bf16 v[100:103], v[56:59], v[212:215], v[100:103]
    v_cvt_f32_u32 v18, v18
    v_cvt_f32_u32 v19, v19
    v_mfma_f32_16x16x32_bf16 v[104:107], v[60:63], v[208:211], v[104:107]
    v_fma_f32 v16, v16, v34, -v35
    v_fma_f32 v17, v17, v34, -v35
    v_mfma_f32_16x16x32_bf16 v[108:111], v[60:63], v[212:215], v[108:111]
    v_fma_f32 v18, v18, v34, -v35
    v_fma_f32 v19, v19, v34, -v35
    v_cvt_pk_bf16_f32 v12, v16, v17
    s_waitcnt lgkmcnt(1)
    ds_read_b128 v[48:51], v2 offset:20480
    ds_read_b128 v[52:55], v2 offset:20736
    ds_read_b128 v[56:59], v2 offset:20992
    ds_read_b128 v[60:63], v2 offset:21248
    v_mfma_f32_16x16x32_bf16 v[80:83], v[64:67], v[216:219], v[80:83]
    v_cvt_pk_bf16_f32 v13, v18, v19
    v_bfe_u32 v20, v30, 0, 3
    v_mfma_f32_16x16x32_bf16 v[84:87], v[64:67], v[220:223], v[84:87]
    v_bfe_u32 v21, v30, 3, 3
    v_bfe_u32 v22, v30, 6, 3
    v_mfma_f32_16x16x32_bf16 v[88:91], v[68:71], v[216:219], v[88:91]
    v_bfe_u32 v23, v30, 9, 3
    v_cvt_f32_u32 v20, v20
    v_cvt_f32_u32 v21, v21
    v_mfma_f32_16x16x32_bf16 v[92:95], v[68:71], v[220:223], v[92:95]
    v_cvt_f32_u32 v22, v22
    v_cvt_f32_u32 v23, v23
    v_mfma_f32_16x16x32_bf16 v[96:99], v[72:75], v[216:219], v[96:99]
    v_fma_f32 v20, v20, v34, -v35
    v_fma_f32 v21, v21, v34, -v35
    v_mfma_f32_16x16x32_bf16 v[100:103], v[72:75], v[220:223], v[100:103]
    v_fma_f32 v22, v22, v34, -v35
    v_fma_f32 v23, v23, v34, -v35
    v_cvt_pk_bf16_f32 v14, v20, v21
    v_mfma_f32_16x16x32_bf16 v[104:107], v[76:79], v[216:219], v[104:107]
    v_cvt_pk_bf16_f32 v15, v22, v23
    ds_write_b128 v4, v[12:15] offset:7168
    v_mfma_f32_16x16x32_bf16 v[108:111], v[76:79], v[220:223], v[108:111]
    v_bfe_u32 v16, v30, 12, 3
    v_bfe_u32 v17, v30, 15, 3
    s_waitcnt lgkmcnt(1)
    ds_read_b128 v[64:67], v2 offset:24576
    ds_read_b128 v[68:71], v2 offset:24832
    ds_read_b128 v[72:75], v2 offset:25088
    ds_read_b128 v[76:79], v2 offset:25344
    v_mfma_f32_16x16x32_bf16 v[80:83], v[48:51], v[224:227], v[80:83]
    v_bfe_u32 v18, v30, 18, 3
    v_bfe_u32 v19, v30, 21, 3
    v_cvt_f32_u32 v16, v16
    v_mfma_f32_16x16x32_bf16 v[84:87], v[48:51], v[228:231], v[84:87]
    v_cvt_f32_u32 v17, v17
    v_cvt_f32_u32 v18, v18
    v_mfma_f32_16x16x32_bf16 v[88:91], v[52:55], v[224:227], v[88:91]
    v_cvt_f32_u32 v19, v19
    v_fma_f32 v16, v16, v34, -v35
    v_mfma_f32_16x16x32_bf16 v[92:95], v[52:55], v[228:231], v[92:95]
    v_fma_f32 v17, v17, v34, -v35
    v_fma_f32 v18, v18, v34, -v35
    v_fma_f32 v19, v19, v34, -v35
    v_mfma_f32_16x16x32_bf16 v[96:99], v[56:59], v[224:227], v[96:99]
    v_cvt_pk_bf16_f32 v8, v16, v17
    v_cvt_pk_bf16_f32 v9, v18, v19
    v_mfma_f32_16x16x32_bf16 v[100:103], v[56:59], v[228:231], v[100:103]
    v_bfe_u32 v20, v30, 24, 3
    v_bfe_u32 v21, v30, 27, 3
    v_mfma_f32_16x16x32_bf16 v[104:107], v[60:63], v[224:227], v[104:107]
    v_bfe_u32 v22, v31, 0, 3
    v_bfe_u32 v23, v31, 3, 3
    v_cvt_f32_u32 v20, v20
    v_mfma_f32_16x16x32_bf16 v[108:111], v[60:63], v[228:231], v[108:111]
    v_cvt_f32_u32 v21, v21
    v_cvt_f32_u32 v22, v22
    s_waitcnt lgkmcnt(0)
    ds_read_b128 v[48:51], v2 offset:28672
    ds_read_b128 v[52:55], v2 offset:28928
    ds_read_b128 v[56:59], v2 offset:29184
    ds_read_b128 v[60:63], v2 offset:29440
    v_mfma_f32_16x16x32_bf16 v[80:83], v[64:67], v[232:235], v[80:83]
    v_cvt_f32_u32 v23, v23
    v_fma_f32 v20, v20, v34, -v35
    v_mfma_f32_16x16x32_bf16 v[84:87], v[64:67], v[236:239], v[84:87]
    v_fma_f32 v21, v21, v34, -v35
    v_fma_f32 v22, v22, v34, -v35
    v_fma_f32 v23, v23, v34, -v35
    v_mfma_f32_16x16x32_bf16 v[88:91], v[68:71], v[232:235], v[88:91]
    v_cvt_pk_bf16_f32 v10, v20, v21
    v_cvt_pk_bf16_f32 v11, v22, v23
    v_mfma_f32_16x16x32_bf16 v[92:95], v[68:71], v[236:239], v[92:95]
    ds_write_b128 v4, v[8:11] offset:8192
    v_bfe_u32 v16, v31, 6, 3
    v_mfma_f32_16x16x32_bf16 v[96:99], v[72:75], v[232:235], v[96:99]
    v_bfe_u32 v17, v31, 9, 3
    v_bfe_u32 v18, v31, 12, 3
    v_bfe_u32 v19, v31, 15, 3
    v_mfma_f32_16x16x32_bf16 v[100:103], v[72:75], v[236:239], v[100:103]
    v_cvt_f32_u32 v16, v16
    v_cvt_f32_u32 v17, v17
    v_mfma_f32_16x16x32_bf16 v[104:107], v[76:79], v[232:235], v[104:107]
    v_cvt_f32_u32 v18, v18
    v_cvt_f32_u32 v19, v19
    v_mfma_f32_16x16x32_bf16 v[108:111], v[76:79], v[236:239], v[108:111]
    v_fma_f32 v16, v16, v34, -v35
    v_fma_f32 v17, v17, v34, -v35
    v_fma_f32 v18, v18, v34, -v35
    s_waitcnt lgkmcnt(1)
    ds_read_b128 v[64:67], v2 offset:32768
    ds_read_b128 v[68:71], v2 offset:33024
    ds_read_b128 v[72:75], v2 offset:33280
    ds_read_b128 v[76:79], v2 offset:33536
    v_mfma_f32_16x16x32_bf16 v[80:83], v[48:51], v[240:243], v[80:83]
    v_fma_f32 v19, v19, v34, -v35
    v_cvt_pk_bf16_f32 v12, v16, v17
    v_mfma_f32_16x16x32_bf16 v[84:87], v[48:51], v[244:247], v[84:87]
    v_cvt_pk_bf16_f32 v13, v18, v19
    v_bfe_u32 v20, v31, 18, 3
    v_mfma_f32_16x16x32_bf16 v[88:91], v[52:55], v[240:243], v[88:91]
    v_bfe_u32 v21, v31, 21, 3
    v_bfe_u32 v22, v31, 24, 3
    v_bfe_u32 v23, v31, 27, 3
    v_mfma_f32_16x16x32_bf16 v[92:95], v[52:55], v[244:247], v[92:95]
    v_cvt_f32_u32 v20, v20
    v_cvt_f32_u32 v21, v21
    v_mfma_f32_16x16x32_bf16 v[96:99], v[56:59], v[240:243], v[96:99]
    v_cvt_f32_u32 v22, v22
    v_cvt_f32_u32 v23, v23
    v_mfma_f32_16x16x32_bf16 v[100:103], v[56:59], v[244:247], v[100:103]
    v_fma_f32 v20, v20, v34, -v35
    v_fma_f32 v21, v21, v34, -v35
    v_fma_f32 v22, v22, v34, -v35
    v_mfma_f32_16x16x32_bf16 v[104:107], v[60:63], v[240:243], v[104:107]
    v_fma_f32 v23, v23, v34, -v35
    v_cvt_pk_bf16_f32 v14, v20, v21
    v_mfma_f32_16x16x32_bf16 v[108:111], v[60:63], v[244:247], v[108:111]
    v_cvt_pk_bf16_f32 v15, v22, v23
    ds_write_b128 v4, v[12:15] offset:9216
    s_waitcnt lgkmcnt(1)
    v_mfma_f32_16x16x32_bf16 v[80:83], v[64:67], v[248:251], v[80:83]
    v_mfma_f32_16x16x32_bf16 v[84:87], v[64:67], v[252:255], v[84:87]
    v_mfma_f32_16x16x32_bf16 v[88:91], v[68:71], v[248:251], v[88:91]
    v_mfma_f32_16x16x32_bf16 v[92:95], v[68:71], v[252:255], v[92:95]
    v_mfma_f32_16x16x32_bf16 v[96:99], v[72:75], v[248:251], v[96:99]
    v_mfma_f32_16x16x32_bf16 v[100:103], v[72:75], v[252:255], v[100:103]
    v_mfma_f32_16x16x32_bf16 v[104:107], v[76:79], v[248:251], v[104:107]
    v_mfma_f32_16x16x32_bf16 v[108:111], v[76:79], v[252:255], v[108:111]
    s_nop 7
    s_nop 1
    v_cvt_pk_bf16_f32 v8, v80, v81
    v_cvt_pk_bf16_f32 v9, v82, v83
    v_cvt_pk_bf16_f32 v10, v88, v89
    v_cvt_pk_bf16_f32 v11, v90, v91
    buffer_store_dwordx4 v[8:11], v6, s[32:35], 0 offen offset:128
    v_cvt_pk_bf16_f32 v12, v96, v97
    v_cvt_pk_bf16_f32 v13, v98, v99
    v_cvt_pk_bf16_f32 v14, v104, v105
    v_cvt_pk_bf16_f32 v15, v106, v107
    buffer_store_dwordx4 v[12:15], v6, s[32:35], 0 offen offset:192
    v_cvt_pk_bf16_f32 v16, v84, v85
    v_cvt_pk_bf16_f32 v17, v86, v87
    v_cvt_pk_bf16_f32 v18, v92, v93
    v_cvt_pk_bf16_f32 v19, v94, v95
    buffer_store_dwordx4 v[16:19], v6, s[32:35], s37 offen offset:128
    v_cvt_pk_bf16_f32 v20, v100, v101
    v_cvt_pk_bf16_f32 v21, v102, v103
    v_cvt_pk_bf16_f32 v22, v108, v109
    v_cvt_pk_bf16_f32 v23, v110, v111
    buffer_store_dwordx4 v[20:23], v6, s[32:35], s37 offen offset:192
    s_branch L_P1_DONE
L_P1_NODQ:
    v_add_u32 v1, 81920, v3
    v_add_u32 v2, 118784, v3
    ds_read_b128 v[48:51], v1 offset:0
    ds_read_b128 v[52:55], v1 offset:256
    ds_read_b128 v[56:59], v1 offset:512
    ds_read_b128 v[60:63], v1 offset:768
    s_waitcnt lgkmcnt(0)
    ds_read_b128 v[64:67], v1 offset:4096
    ds_read_b128 v[68:71], v1 offset:4352
    ds_read_b128 v[72:75], v1 offset:4608
    ds_read_b128 v[76:79], v1 offset:4864
    v_mfma_f32_16x16x32_bf16 v[80:83], v[48:51], v[112:115], 0
    v_mfma_f32_16x16x32_bf16 v[84:87], v[48:51], v[116:119], 0
    v_mfma_f32_16x16x32_bf16 v[88:91], v[52:55], v[112:115], 0
    v_mfma_f32_16x16x32_bf16 v[92:95], v[52:55], v[116:119], 0
    v_mfma_f32_16x16x32_bf16 v[96:99], v[56:59], v[112:115], 0
    v_mfma_f32_16x16x32_bf16 v[100:103], v[56:59], v[116:119], 0
    v_mfma_f32_16x16x32_bf16 v[104:107], v[60:63], v[112:115], 0
    v_mfma_f32_16x16x32_bf16 v[108:111], v[60:63], v[116:119], 0
    s_waitcnt lgkmcnt(0)
    ds_read_b128 v[48:51], v1 offset:8192
    ds_read_b128 v[52:55], v1 offset:8448
    ds_read_b128 v[56:59], v1 offset:8704
    ds_read_b128 v[60:63], v1 offset:8960
    v_mfma_f32_16x16x32_bf16 v[80:83], v[64:67], v[120:123], v[80:83]
    v_mfma_f32_16x16x32_bf16 v[84:87], v[64:67], v[124:127], v[84:87]
    v_mfma_f32_16x16x32_bf16 v[88:91], v[68:71], v[120:123], v[88:91]
    v_mfma_f32_16x16x32_bf16 v[92:95], v[68:71], v[124:127], v[92:95]
    v_mfma_f32_16x16x32_bf16 v[96:99], v[72:75], v[120:123], v[96:99]
    v_mfma_f32_16x16x32_bf16 v[100:103], v[72:75], v[124:127], v[100:103]
    v_mfma_f32_16x16x32_bf16 v[104:107], v[76:79], v[120:123], v[104:107]
    v_mfma_f32_16x16x32_bf16 v[108:111], v[76:79], v[124:127], v[108:111]
    s_waitcnt lgkmcnt(0)
    ds_read_b128 v[64:67], v1 offset:12288
    ds_read_b128 v[68:71], v1 offset:12544
    ds_read_b128 v[72:75], v1 offset:12800
    ds_read_b128 v[76:79], v1 offset:13056
    v_mfma_f32_16x16x32_bf16 v[80:83], v[48:51], v[128:131], v[80:83]
    v_mfma_f32_16x16x32_bf16 v[84:87], v[48:51], v[132:135], v[84:87]
    v_mfma_f32_16x16x32_bf16 v[88:91], v[52:55], v[128:131], v[88:91]
    v_mfma_f32_16x16x32_bf16 v[92:95], v[52:55], v[132:135], v[92:95]
    v_mfma_f32_16x16x32_bf16 v[96:99], v[56:59], v[128:131], v[96:99]
    v_mfma_f32_16x16x32_bf16 v[100:103], v[56:59], v[132:135], v[100:103]
    v_mfma_f32_16x16x32_bf16 v[104:107], v[60:63], v[128:131], v[104:107]
    v_mfma_f32_16x16x32_bf16 v[108:111], v[60:63], v[132:135], v[108:111]
    s_waitcnt lgkmcnt(0)
    ds_read_b128 v[48:51], v1 offset:16384
    ds_read_b128 v[52:55], v1 offset:16640
    ds_read_b128 v[56:59], v1 offset:16896
    ds_read_b128 v[60:63], v1 offset:17152
    v_mfma_f32_16x16x32_bf16 v[80:83], v[64:67], v[136:139], v[80:83]
    v_mfma_f32_16x16x32_bf16 v[84:87], v[64:67], v[140:143], v[84:87]
    v_mfma_f32_16x16x32_bf16 v[88:91], v[68:71], v[136:139], v[88:91]
    v_mfma_f32_16x16x32_bf16 v[92:95], v[68:71], v[140:143], v[92:95]
    v_mfma_f32_16x16x32_bf16 v[96:99], v[72:75], v[136:139], v[96:99]
    v_mfma_f32_16x16x32_bf16 v[100:103], v[72:75], v[140:143], v[100:103]
    v_mfma_f32_16x16x32_bf16 v[104:107], v[76:79], v[136:139], v[104:107]
    v_mfma_f32_16x16x32_bf16 v[108:111], v[76:79], v[140:143], v[108:111]
    s_waitcnt lgkmcnt(0)
    ds_read_b128 v[64:67], v1 offset:20480
    ds_read_b128 v[68:71], v1 offset:20736
    ds_read_b128 v[72:75], v1 offset:20992
    ds_read_b128 v[76:79], v1 offset:21248
    v_mfma_f32_16x16x32_bf16 v[80:83], v[48:51], v[144:147], v[80:83]
    v_mfma_f32_16x16x32_bf16 v[84:87], v[48:51], v[148:151], v[84:87]
    v_mfma_f32_16x16x32_bf16 v[88:91], v[52:55], v[144:147], v[88:91]
    v_mfma_f32_16x16x32_bf16 v[92:95], v[52:55], v[148:151], v[92:95]
    v_mfma_f32_16x16x32_bf16 v[96:99], v[56:59], v[144:147], v[96:99]
    v_mfma_f32_16x16x32_bf16 v[100:103], v[56:59], v[148:151], v[100:103]
    v_mfma_f32_16x16x32_bf16 v[104:107], v[60:63], v[144:147], v[104:107]
    v_mfma_f32_16x16x32_bf16 v[108:111], v[60:63], v[148:151], v[108:111]
    s_waitcnt lgkmcnt(0)
    ds_read_b128 v[48:51], v1 offset:24576
    ds_read_b128 v[52:55], v1 offset:24832
    ds_read_b128 v[56:59], v1 offset:25088
    ds_read_b128 v[60:63], v1 offset:25344
    v_mfma_f32_16x16x32_bf16 v[80:83], v[64:67], v[152:155], v[80:83]
    v_mfma_f32_16x16x32_bf16 v[84:87], v[64:67], v[156:159], v[84:87]
    v_mfma_f32_16x16x32_bf16 v[88:91], v[68:71], v[152:155], v[88:91]
    v_mfma_f32_16x16x32_bf16 v[92:95], v[68:71], v[156:159], v[92:95]
    v_mfma_f32_16x16x32_bf16 v[96:99], v[72:75], v[152:155], v[96:99]
    v_mfma_f32_16x16x32_bf16 v[100:103], v[72:75], v[156:159], v[100:103]
    v_mfma_f32_16x16x32_bf16 v[104:107], v[76:79], v[152:155], v[104:107]
    v_mfma_f32_16x16x32_bf16 v[108:111], v[76:79], v[156:159], v[108:111]
    s_waitcnt lgkmcnt(0)
    ds_read_b128 v[64:67], v1 offset:28672
    ds_read_b128 v[68:71], v1 offset:28928
    ds_read_b128 v[72:75], v1 offset:29184
    ds_read_b128 v[76:79], v1 offset:29440
    v_mfma_f32_16x16x32_bf16 v[80:83], v[48:51], v[160:163], v[80:83]
    v_mfma_f32_16x16x32_bf16 v[84:87], v[48:51], v[164:167], v[84:87]
    v_mfma_f32_16x16x32_bf16 v[88:91], v[52:55], v[160:163], v[88:91]
    v_mfma_f32_16x16x32_bf16 v[92:95], v[52:55], v[164:167], v[92:95]
    v_mfma_f32_16x16x32_bf16 v[96:99], v[56:59], v[160:163], v[96:99]
    v_mfma_f32_16x16x32_bf16 v[100:103], v[56:59], v[164:167], v[100:103]
    v_mfma_f32_16x16x32_bf16 v[104:107], v[60:63], v[160:163], v[104:107]
    v_mfma_f32_16x16x32_bf16 v[108:111], v[60:63], v[164:167], v[108:111]
    s_waitcnt lgkmcnt(0)
    ds_read_b128 v[48:51], v1 offset:32768
    ds_read_b128 v[52:55], v1 offset:33024
    ds_read_b128 v[56:59], v1 offset:33280
    ds_read_b128 v[60:63], v1 offset:33536
    v_mfma_f32_16x16x32_bf16 v[80:83], v[64:67], v[168:171], v[80:83]
    v_mfma_f32_16x16x32_bf16 v[84:87], v[64:67], v[172:175], v[84:87]
    v_mfma_f32_16x16x32_bf16 v[88:91], v[68:71], v[168:171], v[88:91]
    v_mfma_f32_16x16x32_bf16 v[92:95], v[68:71], v[172:175], v[92:95]
    v_mfma_f32_16x16x32_bf16 v[96:99], v[72:75], v[168:171], v[96:99]
    v_mfma_f32_16x16x32_bf16 v[100:103], v[72:75], v[172:175], v[100:103]
    v_mfma_f32_16x16x32_bf16 v[104:107], v[76:79], v[168:171], v[104:107]
    v_mfma_f32_16x16x32_bf16 v[108:111], v[76:79], v[172:175], v[108:111]
    s_waitcnt lgkmcnt(0)
    ds_read_b128 v[64:67], v2 offset:0
    ds_read_b128 v[68:71], v2 offset:256
    ds_read_b128 v[72:75], v2 offset:512
    ds_read_b128 v[76:79], v2 offset:768
    v_mfma_f32_16x16x32_bf16 v[80:83], v[48:51], v[176:179], v[80:83]
    v_mfma_f32_16x16x32_bf16 v[84:87], v[48:51], v[180:183], v[84:87]
    v_mfma_f32_16x16x32_bf16 v[88:91], v[52:55], v[176:179], v[88:91]
    v_mfma_f32_16x16x32_bf16 v[92:95], v[52:55], v[180:183], v[92:95]
    v_mfma_f32_16x16x32_bf16 v[96:99], v[56:59], v[176:179], v[96:99]
    v_mfma_f32_16x16x32_bf16 v[100:103], v[56:59], v[180:183], v[100:103]
    v_mfma_f32_16x16x32_bf16 v[104:107], v[60:63], v[176:179], v[104:107]
    v_mfma_f32_16x16x32_bf16 v[108:111], v[60:63], v[180:183], v[108:111]
    s_waitcnt lgkmcnt(0)
    ds_read_b128 v[48:51], v2 offset:4096
    ds_read_b128 v[52:55], v2 offset:4352
    ds_read_b128 v[56:59], v2 offset:4608
    ds_read_b128 v[60:63], v2 offset:4864
    v_mfma_f32_16x16x32_bf16 v[80:83], v[64:67], v[184:187], v[80:83]
    v_mfma_f32_16x16x32_bf16 v[84:87], v[64:67], v[188:191], v[84:87]
    v_mfma_f32_16x16x32_bf16 v[88:91], v[68:71], v[184:187], v[88:91]
    v_mfma_f32_16x16x32_bf16 v[92:95], v[68:71], v[188:191], v[92:95]
    v_mfma_f32_16x16x32_bf16 v[96:99], v[72:75], v[184:187], v[96:99]
    v_mfma_f32_16x16x32_bf16 v[100:103], v[72:75], v[188:191], v[100:103]
    v_mfma_f32_16x16x32_bf16 v[104:107], v[76:79], v[184:187], v[104:107]
    v_mfma_f32_16x16x32_bf16 v[108:111], v[76:79], v[188:191], v[108:111]
    s_waitcnt lgkmcnt(0)
    ds_read_b128 v[64:67], v2 offset:8192
    ds_read_b128 v[68:71], v2 offset:8448
    ds_read_b128 v[72:75], v2 offset:8704
    ds_read_b128 v[76:79], v2 offset:8960
    v_mfma_f32_16x16x32_bf16 v[80:83], v[48:51], v[192:195], v[80:83]
    v_mfma_f32_16x16x32_bf16 v[84:87], v[48:51], v[196:199], v[84:87]
    v_mfma_f32_16x16x32_bf16 v[88:91], v[52:55], v[192:195], v[88:91]
    v_mfma_f32_16x16x32_bf16 v[92:95], v[52:55], v[196:199], v[92:95]
    v_mfma_f32_16x16x32_bf16 v[96:99], v[56:59], v[192:195], v[96:99]
    v_mfma_f32_16x16x32_bf16 v[100:103], v[56:59], v[196:199], v[100:103]
    v_mfma_f32_16x16x32_bf16 v[104:107], v[60:63], v[192:195], v[104:107]
    v_mfma_f32_16x16x32_bf16 v[108:111], v[60:63], v[196:199], v[108:111]
    s_waitcnt lgkmcnt(0)
    ds_read_b128 v[48:51], v2 offset:12288
    ds_read_b128 v[52:55], v2 offset:12544
    ds_read_b128 v[56:59], v2 offset:12800
    ds_read_b128 v[60:63], v2 offset:13056
    v_mfma_f32_16x16x32_bf16 v[80:83], v[64:67], v[200:203], v[80:83]
    v_mfma_f32_16x16x32_bf16 v[84:87], v[64:67], v[204:207], v[84:87]
    v_mfma_f32_16x16x32_bf16 v[88:91], v[68:71], v[200:203], v[88:91]
    v_mfma_f32_16x16x32_bf16 v[92:95], v[68:71], v[204:207], v[92:95]
    v_mfma_f32_16x16x32_bf16 v[96:99], v[72:75], v[200:203], v[96:99]
    v_mfma_f32_16x16x32_bf16 v[100:103], v[72:75], v[204:207], v[100:103]
    v_mfma_f32_16x16x32_bf16 v[104:107], v[76:79], v[200:203], v[104:107]
    v_mfma_f32_16x16x32_bf16 v[108:111], v[76:79], v[204:207], v[108:111]
    s_waitcnt lgkmcnt(0)
    ds_read_b128 v[64:67], v2 offset:16384
    ds_read_b128 v[68:71], v2 offset:16640
    ds_read_b128 v[72:75], v2 offset:16896
    ds_read_b128 v[76:79], v2 offset:17152
    v_mfma_f32_16x16x32_bf16 v[80:83], v[48:51], v[208:211], v[80:83]
    v_mfma_f32_16x16x32_bf16 v[84:87], v[48:51], v[212:215], v[84:87]
    v_mfma_f32_16x16x32_bf16 v[88:91], v[52:55], v[208:211], v[88:91]
    v_mfma_f32_16x16x32_bf16 v[92:95], v[52:55], v[212:215], v[92:95]
    v_mfma_f32_16x16x32_bf16 v[96:99], v[56:59], v[208:211], v[96:99]
    v_mfma_f32_16x16x32_bf16 v[100:103], v[56:59], v[212:215], v[100:103]
    v_mfma_f32_16x16x32_bf16 v[104:107], v[60:63], v[208:211], v[104:107]
    v_mfma_f32_16x16x32_bf16 v[108:111], v[60:63], v[212:215], v[108:111]
    s_waitcnt lgkmcnt(0)
    ds_read_b128 v[48:51], v2 offset:20480
    ds_read_b128 v[52:55], v2 offset:20736
    ds_read_b128 v[56:59], v2 offset:20992
    ds_read_b128 v[60:63], v2 offset:21248
    v_mfma_f32_16x16x32_bf16 v[80:83], v[64:67], v[216:219], v[80:83]
    v_mfma_f32_16x16x32_bf16 v[84:87], v[64:67], v[220:223], v[84:87]
    v_mfma_f32_16x16x32_bf16 v[88:91], v[68:71], v[216:219], v[88:91]
    v_mfma_f32_16x16x32_bf16 v[92:95], v[68:71], v[220:223], v[92:95]
    v_mfma_f32_16x16x32_bf16 v[96:99], v[72:75], v[216:219], v[96:99]
    v_mfma_f32_16x16x32_bf16 v[100:103], v[72:75], v[220:223], v[100:103]
    v_mfma_f32_16x16x32_bf16 v[104:107], v[76:79], v[216:219], v[104:107]
    v_mfma_f32_16x16x32_bf16 v[108:111], v[76:79], v[220:223], v[108:111]
    s_waitcnt lgkmcnt(0)
    ds_read_b128 v[64:67], v2 offset:24576
    ds_read_b128 v[68:71], v2 offset:24832
    ds_read_b128 v[72:75], v2 offset:25088
    ds_read_b128 v[76:79], v2 offset:25344
    v_mfma_f32_16x16x32_bf16 v[80:83], v[48:51], v[224:227], v[80:83]
    v_mfma_f32_16x16x32_bf16 v[84:87], v[48:51], v[228:231], v[84:87]
    v_mfma_f32_16x16x32_bf16 v[88:91], v[52:55], v[224:227], v[88:91]
    v_mfma_f32_16x16x32_bf16 v[92:95], v[52:55], v[228:231], v[92:95]
    v_mfma_f32_16x16x32_bf16 v[96:99], v[56:59], v[224:227], v[96:99]
    v_mfma_f32_16x16x32_bf16 v[100:103], v[56:59], v[228:231], v[100:103]
    v_mfma_f32_16x16x32_bf16 v[104:107], v[60:63], v[224:227], v[104:107]
    v_mfma_f32_16x16x32_bf16 v[108:111], v[60:63], v[228:231], v[108:111]
    s_waitcnt lgkmcnt(0)
    ds_read_b128 v[48:51], v2 offset:28672
    ds_read_b128 v[52:55], v2 offset:28928
    ds_read_b128 v[56:59], v2 offset:29184
    ds_read_b128 v[60:63], v2 offset:29440
    v_mfma_f32_16x16x32_bf16 v[80:83], v[64:67], v[232:235], v[80:83]
    v_mfma_f32_16x16x32_bf16 v[84:87], v[64:67], v[236:239], v[84:87]
    v_mfma_f32_16x16x32_bf16 v[88:91], v[68:71], v[232:235], v[88:91]
    v_mfma_f32_16x16x32_bf16 v[92:95], v[68:71], v[236:239], v[92:95]
    v_mfma_f32_16x16x32_bf16 v[96:99], v[72:75], v[232:235], v[96:99]
    v_mfma_f32_16x16x32_bf16 v[100:103], v[72:75], v[236:239], v[100:103]
    v_mfma_f32_16x16x32_bf16 v[104:107], v[76:79], v[232:235], v[104:107]
    v_mfma_f32_16x16x32_bf16 v[108:111], v[76:79], v[236:239], v[108:111]
    s_waitcnt lgkmcnt(0)
    ds_read_b128 v[64:67], v2 offset:32768
    ds_read_b128 v[68:71], v2 offset:33024
    ds_read_b128 v[72:75], v2 offset:33280
    ds_read_b128 v[76:79], v2 offset:33536
    v_mfma_f32_16x16x32_bf16 v[80:83], v[48:51], v[240:243], v[80:83]
    v_mfma_f32_16x16x32_bf16 v[84:87], v[48:51], v[244:247], v[84:87]
    v_mfma_f32_16x16x32_bf16 v[88:91], v[52:55], v[240:243], v[88:91]
    v_mfma_f32_16x16x32_bf16 v[92:95], v[52:55], v[244:247], v[92:95]
    v_mfma_f32_16x16x32_bf16 v[96:99], v[56:59], v[240:243], v[96:99]
    v_mfma_f32_16x16x32_bf16 v[100:103], v[56:59], v[244:247], v[100:103]
    v_mfma_f32_16x16x32_bf16 v[104:107], v[60:63], v[240:243], v[104:107]
    v_mfma_f32_16x16x32_bf16 v[108:111], v[60:63], v[244:247], v[108:111]
    s_waitcnt lgkmcnt(0)
    v_mfma_f32_16x16x32_bf16 v[80:83], v[64:67], v[248:251], v[80:83]
    v_mfma_f32_16x16x32_bf16 v[84:87], v[64:67], v[252:255], v[84:87]
    v_mfma_f32_16x16x32_bf16 v[88:91], v[68:71], v[248:251], v[88:91]
    v_mfma_f32_16x16x32_bf16 v[92:95], v[68:71], v[252:255], v[92:95]
    v_mfma_f32_16x16x32_bf16 v[96:99], v[72:75], v[248:251], v[96:99]
    v_mfma_f32_16x16x32_bf16 v[100:103], v[72:75], v[252:255], v[100:103]
    v_mfma_f32_16x16x32_bf16 v[104:107], v[76:79], v[248:251], v[104:107]
    v_mfma_f32_16x16x32_bf16 v[108:111], v[76:79], v[252:255], v[108:111]
    s_nop 7
    s_nop 1
    v_cvt_pk_bf16_f32 v8, v80, v81
    v_cvt_pk_bf16_f32 v9, v82, v83
    v_cvt_pk_bf16_f32 v10, v88, v89
    v_cvt_pk_bf16_f32 v11, v90, v91
    buffer_store_dwordx4 v[8:11], v6, s[32:35], 0 offen offset:128
    v_cvt_pk_bf16_f32 v12, v96, v97
    v_cvt_pk_bf16_f32 v13, v98, v99
    v_cvt_pk_bf16_f32 v14, v104, v105
    v_cvt_pk_bf16_f32 v15, v106, v107
    buffer_store_dwordx4 v[12:15], v6, s[32:35], 0 offen offset:192
    v_cvt_pk_bf16_f32 v16, v84, v85
    v_cvt_pk_bf16_f32 v17, v86, v87
    v_cvt_pk_bf16_f32 v18, v92, v93
    v_cvt_pk_bf16_f32 v19, v94, v95
    buffer_store_dwordx4 v[16:19], v6, s[32:35], s37 offen offset:128
    v_cvt_pk_bf16_f32 v20, v100, v101
    v_cvt_pk_bf16_f32 v21, v102, v103
    v_cvt_pk_bf16_f32 v22, v108, v109
    v_cvt_pk_bf16_f32 v23, v110, v111
    buffer_store_dwordx4 v[20:23], v6, s[32:35], s37 offen offset:192
L_P1_DONE:
    s_waitcnt lgkmcnt(0)
    s_barrier
    v_and_b32 v16, 15, v0
    v_and_b32 v17, 63, v0
    v_lshrrev_b32 v17, 4, v17
    v_add_u32 v16, s47, v16
    v_mul_u32_u24 v16, 4608, v16
    v_add_u32 v16, s48, v16
    v_lshl_add_u32 v16, v17, 2, v16
    v_add_u32 v16, 128, v16
    v_lshlrev_b32 v6, 1, v16
    v_add_u32 v1, 0, v3
    v_add_u32 v2, 36864, v3
    ds_read_b128 v[48:51], v1 offset:0
    s_waitcnt lgkmcnt(0)
    ds_read_b128 v[64:67], v1 offset:4096
    v_mfma_f32_16x16x32_bf16 v[80:83], v[48:51], v[112:115], 0
    v_mfma_f32_16x16x32_bf16 v[84:87], v[48:51], v[116:119], 0
    s_waitcnt lgkmcnt(0)
    ds_read_b128 v[48:51], v1 offset:8192
    v_mfma_f32_16x16x32_bf16 v[80:83], v[64:67], v[120:123], v[80:83]
    v_mfma_f32_16x16x32_bf16 v[84:87], v[64:67], v[124:127], v[84:87]
    s_waitcnt lgkmcnt(0)
    ds_read_b128 v[64:67], v1 offset:12288
    v_mfma_f32_16x16x32_bf16 v[80:83], v[48:51], v[128:131], v[80:83]
    v_mfma_f32_16x16x32_bf16 v[84:87], v[48:51], v[132:135], v[84:87]
    s_waitcnt lgkmcnt(0)
    ds_read_b128 v[48:51], v1 offset:16384
    v_mfma_f32_16x16x32_bf16 v[80:83], v[64:67], v[136:139], v[80:83]
    v_mfma_f32_16x16x32_bf16 v[84:87], v[64:67], v[140:143], v[84:87]
    s_waitcnt lgkmcnt(0)
    ds_read_b128 v[64:67], v1 offset:20480
    v_mfma_f32_16x16x32_bf16 v[80:83], v[48:51], v[144:147], v[80:83]
    v_mfma_f32_16x16x32_bf16 v[84:87], v[48:51], v[148:151], v[84:87]
    s_waitcnt lgkmcnt(0)
    ds_read_b128 v[48:51], v1 offset:24576
    v_mfma_f32_16x16x32_bf16 v[80:83], v[64:67], v[152:155], v[80:83]
    v_mfma_f32_16x16x32_bf16 v[84:87], v[64:67], v[156:159], v[84:87]
    s_waitcnt lgkmcnt(0)
    ds_read_b128 v[64:67], v1 offset:28672
    v_mfma_f32_16x16x32_bf16 v[80:83], v[48:51], v[160:163], v[80:83]
    v_mfma_f32_16x16x32_bf16 v[84:87], v[48:51], v[164:167], v[84:87]
    s_waitcnt lgkmcnt(0)
    ds_read_b128 v[48:51], v1 offset:32768
    v_mfma_f32_16x16x32_bf16 v[80:83], v[64:67], v[168:171], v[80:83]
    v_mfma_f32_16x16x32_bf16 v[84:87], v[64:67], v[172:175], v[84:87]
    s_waitcnt lgkmcnt(0)
    ds_read_b128 v[64:67], v2 offset:0
    v_mfma_f32_16x16x32_bf16 v[80:83], v[48:51], v[176:179], v[80:83]
    v_mfma_f32_16x16x32_bf16 v[84:87], v[48:51], v[180:183], v[84:87]
    s_waitcnt lgkmcnt(0)
    ds_read_b128 v[48:51], v2 offset:4096
    v_mfma_f32_16x16x32_bf16 v[80:83], v[64:67], v[184:187], v[80:83]
    v_mfma_f32_16x16x32_bf16 v[84:87], v[64:67], v[188:191], v[84:87]
    s_waitcnt lgkmcnt(0)
    ds_read_b128 v[64:67], v2 offset:8192
    v_mfma_f32_16x16x32_bf16 v[80:83], v[48:51], v[192:195], v[80:83]
    v_mfma_f32_16x16x32_bf16 v[84:87], v[48:51], v[196:199], v[84:87]
    s_waitcnt lgkmcnt(0)
    ds_read_b128 v[48:51], v2 offset:12288
    v_mfma_f32_16x16x32_bf16 v[80:83], v[64:67], v[200:203], v[80:83]
    v_mfma_f32_16x16x32_bf16 v[84:87], v[64:67], v[204:207], v[84:87]
    s_waitcnt lgkmcnt(0)
    ds_read_b128 v[64:67], v2 offset:16384
    v_mfma_f32_16x16x32_bf16 v[80:83], v[48:51], v[208:211], v[80:83]
    v_mfma_f32_16x16x32_bf16 v[84:87], v[48:51], v[212:215], v[84:87]
    s_waitcnt lgkmcnt(0)
    ds_read_b128 v[48:51], v2 offset:20480
    v_mfma_f32_16x16x32_bf16 v[80:83], v[64:67], v[216:219], v[80:83]
    v_mfma_f32_16x16x32_bf16 v[84:87], v[64:67], v[220:223], v[84:87]
    s_waitcnt lgkmcnt(0)
    ds_read_b128 v[64:67], v2 offset:24576
    v_mfma_f32_16x16x32_bf16 v[80:83], v[48:51], v[224:227], v[80:83]
    v_mfma_f32_16x16x32_bf16 v[84:87], v[48:51], v[228:231], v[84:87]
    s_waitcnt lgkmcnt(0)
    ds_read_b128 v[48:51], v2 offset:28672
    v_mfma_f32_16x16x32_bf16 v[80:83], v[64:67], v[232:235], v[80:83]
    v_mfma_f32_16x16x32_bf16 v[84:87], v[64:67], v[236:239], v[84:87]
    s_waitcnt lgkmcnt(0)
    ds_read_b128 v[64:67], v2 offset:32768
    v_mfma_f32_16x16x32_bf16 v[80:83], v[48:51], v[240:243], v[80:83]
    v_mfma_f32_16x16x32_bf16 v[84:87], v[48:51], v[244:247], v[84:87]
    s_waitcnt lgkmcnt(0)
    v_mfma_f32_16x16x32_bf16 v[80:83], v[64:67], v[248:251], v[80:83]
    v_mfma_f32_16x16x32_bf16 v[84:87], v[64:67], v[252:255], v[84:87]
    s_nop 7
    s_nop 1
    v_cvt_pk_bf16_f32 v8, v80, v81
    v_cvt_pk_bf16_f32 v9, v82, v83
    buffer_store_dwordx2 v[8:9], v6, s[32:35], 0 offen
    v_cvt_pk_bf16_f32 v12, v84, v85
    v_cvt_pk_bf16_f32 v13, v86, v87
    buffer_store_dwordx2 v[12:13], v6, s[32:35], s37 offen
L_END:
    s_endpgm
.section .rodata,"a"
.p2align 6
.amdhsa_kernel standalone__weight_only_int_gptq__prompt_kernel
  .amdhsa_next_free_vgpr 256
  .amdhsa_next_free_sgpr 102
  .amdhsa_accum_offset 256
  .amdhsa_group_segment_fixed_size 0
  .amdhsa_kernarg_size 64
  .amdhsa_user_sgpr_count 2
  .amdhsa_user_sgpr_kernarg_segment_ptr 1
  .amdhsa_system_sgpr_workgroup_id_x 1
.end_amdhsa_kernel
```
